```python
import torch

def _softmax(x, axis=-1):
    return torch.softmax(x, dim=axis)
def _gelu(x):
    return torch.nn.functional.gelu(x, approximate="tanh")
def _silu(x):
    return torch.nn.functional.silu(x)
def _sigmoid(x):
    return torch.sigmoid(x)
def _layernorm(x, axis=-1, eps=1e-5):
    m = x.mean(dim=axis, keepdim=True)
    v = x.var(dim=axis, keepdim=True, unbiased=False)
    return (x - m) / torch.sqrt(v + eps)
def _scatter_add(tgt, idx, src, axis=0):
    return tgt.clone().index_add_(axis, idx, src)
def _segment_sum(src, seg, n):
    out = torch.zeros((n,) + src.shape[1:], dtype=src.dtype)
    return out.index_add_(0, seg, src)
def _pad(x, pw):
    flat = tuple(v for pair in reversed(pw) for v in pair)
    return torch.nn.functional.pad(x, flat)

kernel_name = 'parallel_sum__grouped_kv_mqa__dense_activation_squared_relu__prompt'

def setup_inputs():

    _w = (lambda a: (lambda t: t.to(torch.bfloat16) if t.is_floating_point() else t)(torch.as_tensor(a)))
    def _A_setup():
        B, S, D, H = 1, 2048, 512, 32
        Dh = D // H
        return {
            "x": _w((lambda *s: torch.randn(*s, dtype=torch.bfloat16) * 0.05)(B, S, D)),
            "wq": _w((lambda *s: torch.randn(*s, dtype=torch.bfloat16) * 0.2)(D, H * Dh)),
            "wk": _w((lambda *s: torch.randn(*s, dtype=torch.bfloat16) * 0.2)(D, Dh)),
            "wv": _w((lambda *s: torch.randn(*s, dtype=torch.bfloat16) * 0.1)(D, Dh)),
            "wo": _w((lambda *s: torch.randn(*s, dtype=torch.bfloat16) * 0.1)(H * Dh, D)),
        }
    _A_in = _A_setup()

    def _B_setup():
        B, S, D, F = 1, 2048, 512, 1376
        return {
            "x": _w((lambda *s: torch.randn(*s, dtype=torch.bfloat16) * 0.05)(B, S, D)),
            "w1": _w((lambda *s: torch.randn(*s, dtype=torch.bfloat16) * 0.05)(D, F)),
            "b1": _w((lambda *s: torch.randn(*s, dtype=torch.bfloat16) * 1.6)(F)),
            "w2": _w((lambda *s: torch.randn(*s, dtype=torch.bfloat16) * 0.05)(F, D)),
            "b2": _w((lambda *s: torch.randn(*s, dtype=torch.bfloat16) * 6.4)(D)),
        }
    _B_in = _B_setup()

    return {
        "A_x": _A_in["x"],
        "A_wq": _A_in["wq"],
        "A_wk": _A_in["wk"],
        "A_wv": _A_in["wv"],
        "A_wo": _A_in["wo"],
        "B_x": _B_in["x"],
        "B_w1": _B_in["w1"],
        "B_b1": _B_in["b1"],
        "B_w2": _B_in["w2"],
        "B_b2": _B_in["b2"],
    }

def reference(A_x, A_wq, A_wk, A_wv, A_wo, B_x, B_w1, B_b1, B_w2, B_b2):
    def _A_ref(x, wq, wk, wv, wo):
        B, S, D = x.shape
        H = 32
        Dh = D // H
        q = (lambda x, *d: x.permute(*d))((x @ wq).reshape(B, S, H, Dh), 0, 2, 1, 3)
        k = x @ wk
        v = x @ wv
        scores = torch.einsum("bhqd,bkd->bhqk", q, k) * (Dh ** -0.5)
        p = _softmax(scores, axis=-1)
        o = torch.einsum("bhqk,bkd->bhqd", p, v)
        return (lambda x, *d: x.permute(*d))(o, 0, 2, 1, 3).reshape(B, S, H * Dh) @ wo

    def _B_ref(x, w1, b1, w2, b2):
        h = torch.einsum("bsd,df->bsf", x, w1) + b1
        zero = torch.zeros_like(h)
        r = torch.where(h > zero, h, zero)
        h = r * r
        out = torch.einsum("bsf,fd->bsd", h, w2) + b2
        return out

    x = A_x
    xn = _layernorm(x, axis=-1)
    return x + _A_ref(xn, A_wq, A_wk, A_wv, A_wo) + _B_ref(xn, B_w1, B_b1, B_w2, B_b2)
```

```asm
; @launch grid=(256,1,1) block=(768,1,1) lds=163840
.amdgcn_target "amdgcn-amd-amdhsa--gfx950"
.text
.globl parallel_sum__grouped_kv_mqa__dense_activation_squared_relu__prompt_kernel
.p2align 8
.type parallel_sum__grouped_kv_mqa__dense_activation_squared_relu__prompt_kernel,@function
parallel_sum__grouped_kv_mqa__dense_activation_squared_relu__prompt_kernel:
    s_cmp_ge_u32 s2, 256
    s_cbranch_scc1 L_end
    s_load_dwordx8 s[4:11], s[0:1], 0
    s_load_dwordx8 s[16:23], s[0:1], 48
    s_load_dwordx2 s[26:27], s[0:1], 96
    s_load_dwordx2 s[12:13], s[0:1], 32
    s_load_dwordx2 s[24:25], s[0:1], 80
    v_lshrrev_b32 v2, 6, v0
    v_and_b32 v1, 63, v0
    v_readfirstlane_b32 s54, v2
    s_and_b32 s3, s2, 7
    s_lshr_b32 s53, s2, 3
    s_lshr_b32 s52, s53, 3
    s_lshl_b32 s3, s3, 2
    s_add_u32 s52, s52, s3
    s_and_b32 s53, s53, 7
    v_lshlrev_b32 v2, 4, v1
    s_mov_b32 s30, 2097152
    s_mov_b32 s31, 0x00020000
    s_mov_b32 s39, 0x00020000
    s_mov_b32 s35, 0x00020000
    s_and_b32 s60, s54, 3
    v_mov_b32 v152, 162816
    v_mov_b32 v153, 1
    v_mov_b32 v159, 0
    v_lshrrev_b32 v22, 3, v1
    v_and_b32 v20, 7, v1
    s_cmp_lt_u32 s54, 4
    s_cbranch_scc1 S_old
    s_and_b32 s59, s54, 7
    s_and_b32 s3, s53, 6
    s_xor_b32 s59, s59, s3
    s_xor_b32 s59, s59, 2
    v_lshlrev_b32 v23, 4, v20
    v_lshl_add_u32 v23, v22, 10, v23
    s_lshl_b32 s64, s52, 3
    s_add_u32 s64, s64, s59
    s_lshl_b32 s64, s64, 13
    s_lshr_b32 s3, s54, 1
    s_cmp_eq_u32 s3, 5
    s_cbranch_scc0 S_r0
    s_setprio 3
    s_waitcnt lgkmcnt(0)
    s_mov_b32 s28, s4
    s_and_b32 s29, s5, 0xffff
    buffer_load_dwordx4 v[120:123], v23, s[28:31], s64 offen offset:0
    buffer_load_dwordx4 v[124:127], v23, s[28:31], s64 offen offset:128
    buffer_load_dwordx4 v[128:131], v23, s[28:31], s64 offen offset:256
    buffer_load_dwordx4 v[132:135], v23, s[28:31], s64 offen offset:384
    buffer_load_dwordx4 v[136:139], v23, s[28:31], s64 offen offset:512
    buffer_load_dwordx4 v[140:143], v23, s[28:31], s64 offen offset:640
    buffer_load_dwordx4 v[144:147], v23, s[28:31], s64 offen offset:768
    buffer_load_dwordx4 v[148:151], v23, s[28:31], s64 offen offset:896
    s_mov_b32 s0, 1
    s_barrier
    s_branch S_r3
S_r0:
    v_add_u32 v18, 162816, v2
    ds_write_b32 v18, v159
    s_setprio 1
    s_cmp_ge_u32 s54, 8
    s_cbranch_scc0 S_r1
    s_setprio 2
S_r1:
    s_waitcnt lgkmcnt(0)
    s_mov_b32 s28, s4
    s_and_b32 s29, s5, 0xffff
    s_cmp_ge_u32 s54, 8
    s_cselect_b32 s0, 1, 0
    s_barrier
    buffer_load_dwordx4 v[120:123], v23, s[28:31], s64 offen offset:0
    buffer_load_dwordx4 v[124:127], v23, s[28:31], s64 offen offset:128
    buffer_load_dwordx4 v[128:131], v23, s[28:31], s64 offen offset:256
    buffer_load_dwordx4 v[132:135], v23, s[28:31], s64 offen offset:384
    buffer_load_dwordx4 v[136:139], v23, s[28:31], s64 offen offset:512
    buffer_load_dwordx4 v[140:143], v23, s[28:31], s64 offen offset:640
    buffer_load_dwordx4 v[144:147], v23, s[28:31], s64 offen offset:768
    buffer_load_dwordx4 v[148:151], v23, s[28:31], s64 offen offset:896
S_r3:
    s_mov_b64 exec, 1
    ds_add_u32 v152, v153 offset:0
    s_mov_b64 exec, -1
    s_branch M_setup
S_old:
    s_setprio 2
    s_movk_i32 s38, 16384
    s_mov_b32 m0, 131072
    s_waitcnt lgkmcnt(0)
    s_mov_b32 s28, s4
    s_and_b32 s29, s5, 0xffff
    s_cmp_eq_u32 s54, 3
    s_cbranch_scc1 S_unit
    s_mov_b32 s32, s6
    s_and_b32 s33, s7, 0xffff
    s_mov_b32 s34, 524288
    s_cmp_lg_u32 s54, 0
    s_cbranch_scc1 S_o1
    v_and_b32 v14, 15, v1
    v_lshlrev_b32 v14, 7, v14
    s_lshl_b32 s3, s2, 11
    buffer_load_dword v0, v14, s[32:35], s3 offen
    s_load_dword s8, s[26:27], 0
    s_load_dword s10, s[16:17], 0
    s_load_dword s11, s[18:19], 0
    s_mov_b32 s3, 0x200000
    s_load_dword s9, s[26:27], s3
    s_mov_b32 s3, 0x400000
    s_load_dword s48, s[26:27], s3
    s_mov_b32 s3, 0x600000
    s_load_dword s49, s[26:27], s3
    s_load_dword s50, s[20:21], 0
    s_load_dword s51, s[22:23], 0
    s_load_dword s55, s[12:13], 0
    s_load_dword s1, s[24:25], 0
S_o1:
    s_mov_b32 s0, 2
    s_barrier
    s_branch M_setup
S_unit:
    s_setprio 3
    s_bitcmp1_b32 s53, 0
    s_cselect_b32 s36, s10, s8
    s_cselect_b32 s37, s11, s9
    s_and_b32 s37, s37, 0xffff
    s_mov_b32 s62, 0
    s_add_u32 s14, s26, 10092544
    s_addc_u32 s15, s27, 0
    s_load_dword s55, s[14:15], 0
    buffer_load_dwordx4 v2, s[36:39], s62 offen offset:0 lds
    buffer_load_dwordx4 v2, s[36:39], s62 offen offset:1024 lds
    buffer_load_dwordx4 v2, s[36:39], s62 offen offset:2048 lds
    buffer_load_dwordx4 v2, s[36:39], s62 offen offset:3072 lds
    s_add_u32 s62, s62, 4096
    s_add_u32 m0, s62, 131072
    s_nop 0
    buffer_load_dwordx4 v2, s[36:39], s62 offen offset:0 lds
    buffer_load_dwordx4 v2, s[36:39], s62 offen offset:1024 lds
    buffer_load_dwordx4 v2, s[36:39], s62 offen offset:2048 lds
    buffer_load_dwordx4 v2, s[36:39], s62 offen offset:3072 lds
    s_add_u32 s62, s62, 4096
    s_add_u32 m0, s62, 131072
    s_nop 0
    buffer_load_dwordx4 v2, s[36:39], s62 offen offset:0 lds
    buffer_load_dwordx4 v2, s[36:39], s62 offen offset:1024 lds
    buffer_load_dwordx4 v2, s[36:39], s62 offen offset:2048 lds
    buffer_load_dwordx4 v2, s[36:39], s62 offen offset:3072 lds
    s_add_u32 s62, s62, 4096
    s_add_u32 m0, s62, 131072
    s_nop 0
    buffer_load_dwordx4 v2, s[36:39], s62 offen offset:0 lds
    buffer_load_dwordx4 v2, s[36:39], s62 offen offset:1024 lds
    buffer_load_dwordx4 v2, s[36:39], s62 offen offset:2048 lds
    buffer_load_dwordx4 v2, s[36:39], s62 offen offset:3072 lds
    s_barrier
    v_and_b32 v154, 15, v1
    v_lshrrev_b32 v155, 4, v1
    v_xor_b32 v9, v154, v155
    v_lshlrev_b32 v9, 4, v9
    v_lshl_add_u32 v9, v154, 8, v9
    s_mov_b32 s44, s26
    s_and_b32 s45, s27, 0xffff
    s_mov_b32 s46, 10616832
    s_mov_b32 s47, 0x00020000
    v_lshlrev_b32 v4, 8, v155
    v_lshl_add_u32 v4, v154, 3, v4
    v_add_u32 v4, 131072, v4
    s_lshr_b32 s64, s53, 1
    s_lshl_b32 s3, s64, 12
    s_add_u32 s3, s3, 65536
    v_add_u32 v12, s3, v9
    v_xor_b32 v13, 64, v12
    v_xor_b32 v14, 128, v12
    v_xor_b32 v15, 192, v12
    s_lshl_b32 s3, s52, 1
    s_lshr_b32 s59, s64, 1
    s_add_u32 s59, s59, s3
    s_and_b32 s64, s64, 1
    v_and_b32 v5, 1, v155
    v_lshrrev_b32 v6, 1, v155
    v_lshlrev_b32 v7, 4, v154
    s_waitcnt vmcnt(12)
    ds_read_b64_tr_b16 v[24:25], v4 offset:0
    ds_read_b64_tr_b16 v[26:27], v4 offset:128
    ds_read_b64_tr_b16 v[28:29], v4 offset:1024
    ds_read_b64_tr_b16 v[30:31], v4 offset:1152
    ds_read_b64_tr_b16 v[32:33], v4 offset:2048
    ds_read_b64_tr_b16 v[34:35], v4 offset:2176
    ds_read_b64_tr_b16 v[36:37], v4 offset:3072
    ds_read_b64_tr_b16 v[38:39], v4 offset:3200
    s_waitcnt vmcnt(8)
    ds_read_b64_tr_b16 v[40:41], v4 offset:4096
    ds_read_b64_tr_b16 v[42:43], v4 offset:4224
    ds_read_b64_tr_b16 v[44:45], v4 offset:5120
    ds_read_b64_tr_b16 v[46:47], v4 offset:5248
    ds_read_b64_tr_b16 v[48:49], v4 offset:6144
    ds_read_b64_tr_b16 v[50:51], v4 offset:6272
    ds_read_b64_tr_b16 v[52:53], v4 offset:7168
    ds_read_b64_tr_b16 v[54:55], v4 offset:7296
    s_waitcnt vmcnt(4)
    ds_read_b64_tr_b16 v[56:57], v4 offset:8192
    ds_read_b64_tr_b16 v[58:59], v4 offset:8320
    ds_read_b64_tr_b16 v[60:61], v4 offset:9216
    ds_read_b64_tr_b16 v[62:63], v4 offset:9344
    ds_read_b64_tr_b16 v[64:65], v4 offset:10240
    ds_read_b64_tr_b16 v[66:67], v4 offset:10368
    ds_read_b64_tr_b16 v[68:69], v4 offset:11264
    ds_read_b64_tr_b16 v[70:71], v4 offset:11392
    s_waitcnt vmcnt(0)
    ds_read_b64_tr_b16 v[104:105], v4 offset:12288
    ds_read_b64_tr_b16 v[106:107], v4 offset:12416
    ds_read_b64_tr_b16 v[108:109], v4 offset:13312
    ds_read_b64_tr_b16 v[110:111], v4 offset:13440
    ds_read_b64_tr_b16 v[112:113], v4 offset:14336
    ds_read_b64_tr_b16 v[114:115], v4 offset:14464
    ds_read_b64_tr_b16 v[116:117], v4 offset:15360
    ds_read_b64_tr_b16 v[118:119], v4 offset:15488
    s_waitcnt lgkmcnt(0)
    s_mul_i32 s55, s55, 1664525
    s_add_u32 s55, s55, 1013904223
    v_mov_b32 v23, s55
    ds_write_b32 v152, v23 offset:176
    s_mov_b64 exec, 1
    ds_add_u32 v152, v153 offset:64
    s_mov_b64 exec, -1
    s_lshl_b32 s65, s59, 11
    s_lshl_b32 s3, s59, 2
    s_and_b32 s59, s53, 3
    s_add_u32 s3, s3, s59
    s_lshl_b32 s59, s3, 7
    s_add_u32 s59, s59, 10108928
    s_lshl_b32 s15, s3, 10
    s_add_u32 s15, s15, 10354688
W_l1:
    ds_read_b32 v161, v152 offset:48
    s_waitcnt lgkmcnt(0)
    v_readfirstlane_b32 s14, v161
    s_cmp_ge_u32 s14, 2
    s_cbranch_scc1 W_o1
    s_sleep 1
    s_branch W_l1
W_o1:
    ds_read_b128 v[120:123], v12 offset:0
    ds_read_b128 v[124:127], v13 offset:0
    ds_read_b128 v[128:131], v14 offset:0
    ds_read_b128 v[132:135], v15 offset:0
    ds_read_b128 v[136:139], v12 offset:16384
    ds_read_b128 v[140:143], v13 offset:16384
    ds_read_b128 v[144:147], v14 offset:16384
    ds_read_b128 v[148:151], v15 offset:16384
    s_bitcmp1_b32 s53, 0
    s_cbranch_scc1 A_vjob
    s_waitcnt lgkmcnt(7)
    v_mfma_f32_16x16x32_bf16 v[16:19], v[24:27], v[120:123], 0
    ds_read_b128 v[120:123], v12 offset:32768
    s_waitcnt lgkmcnt(7)
    v_mfma_f32_16x16x32_bf16 v[16:19], v[28:31], v[124:127], v[16:19]
    ds_read_b128 v[124:127], v13 offset:32768
    s_waitcnt lgkmcnt(7)
    v_mfma_f32_16x16x32_bf16 v[16:19], v[32:35], v[128:131], v[16:19]
    ds_read_b128 v[128:131], v14 offset:32768
    s_waitcnt lgkmcnt(7)
    v_mfma_f32_16x16x32_bf16 v[16:19], v[36:39], v[132:135], v[16:19]
    ds_read_b128 v[132:135], v15 offset:32768
    s_waitcnt lgkmcnt(7)
    v_mfma_f32_16x16x32_bf16 v[16:19], v[40:43], v[136:139], v[16:19]
    ds_read_b128 v[136:139], v12 offset:49152
    s_waitcnt lgkmcnt(7)
    v_mfma_f32_16x16x32_bf16 v[16:19], v[44:47], v[140:143], v[16:19]
    ds_read_b128 v[140:143], v13 offset:49152
    s_waitcnt lgkmcnt(7)
    v_mfma_f32_16x16x32_bf16 v[16:19], v[48:51], v[144:147], v[16:19]
    ds_read_b128 v[144:147], v14 offset:49152
    s_waitcnt lgkmcnt(7)
    v_mfma_f32_16x16x32_bf16 v[16:19], v[52:55], v[148:151], v[16:19]
    ds_read_b128 v[148:151], v15 offset:49152
    s_waitcnt lgkmcnt(7)
    v_mfma_f32_16x16x32_bf16 v[16:19], v[56:59], v[120:123], v[16:19]
    s_waitcnt lgkmcnt(6)
    v_mfma_f32_16x16x32_bf16 v[16:19], v[60:63], v[124:127], v[16:19]
    s_waitcnt lgkmcnt(5)
    v_mfma_f32_16x16x32_bf16 v[16:19], v[64:67], v[128:131], v[16:19]
    s_waitcnt lgkmcnt(4)
    v_mfma_f32_16x16x32_bf16 v[16:19], v[68:71], v[132:135], v[16:19]
    s_waitcnt lgkmcnt(3)
    v_mfma_f32_16x16x32_bf16 v[16:19], v[104:107], v[136:139], v[16:19]
    s_waitcnt lgkmcnt(2)
    v_mfma_f32_16x16x32_bf16 v[16:19], v[108:111], v[140:143], v[16:19]
    s_waitcnt lgkmcnt(1)
    v_mfma_f32_16x16x32_bf16 v[16:19], v[112:115], v[144:147], v[16:19]
    s_waitcnt lgkmcnt(0)
    v_mfma_f32_16x16x32_bf16 v[16:19], v[116:119], v[148:151], v[16:19]
    v_lshl_add_u32 v7, v5, 3, v7
    v_lshl_add_u32 v7, v6, 9, v7
    s_lshl_b32 s3, s64, 8
    s_mov_b32 s64, 1.0
    s_branch A_kvst
A_vjob:
    s_waitcnt lgkmcnt(7)
    v_mfma_f32_16x16x32_bf16 v[16:19], v[120:123], v[24:27], 0
    ds_read_b128 v[120:123], v12 offset:32768
    s_waitcnt lgkmcnt(7)
    v_mfma_f32_16x16x32_bf16 v[16:19], v[124:127], v[28:31], v[16:19]
    ds_read_b128 v[124:127], v13 offset:32768
    s_waitcnt lgkmcnt(7)
    v_mfma_f32_16x16x32_bf16 v[16:19], v[128:131], v[32:35], v[16:19]
    ds_read_b128 v[128:131], v14 offset:32768
    s_waitcnt lgkmcnt(7)
    v_mfma_f32_16x16x32_bf16 v[16:19], v[132:135], v[36:39], v[16:19]
    ds_read_b128 v[132:135], v15 offset:32768
    s_waitcnt lgkmcnt(7)
    v_mfma_f32_16x16x32_bf16 v[16:19], v[136:139], v[40:43], v[16:19]
    ds_read_b128 v[136:139], v12 offset:49152
    s_waitcnt lgkmcnt(7)
    v_mfma_f32_16x16x32_bf16 v[16:19], v[140:143], v[44:47], v[16:19]
    ds_read_b128 v[140:143], v13 offset:49152
    s_waitcnt lgkmcnt(7)
    v_mfma_f32_16x16x32_bf16 v[16:19], v[144:147], v[48:51], v[16:19]
    ds_read_b128 v[144:147], v14 offset:49152
    s_waitcnt lgkmcnt(7)
    v_mfma_f32_16x16x32_bf16 v[16:19], v[148:151], v[52:55], v[16:19]
    ds_read_b128 v[148:151], v15 offset:49152
    s_waitcnt lgkmcnt(7)
    v_mfma_f32_16x16x32_bf16 v[16:19], v[120:123], v[56:59], v[16:19]
    s_waitcnt lgkmcnt(6)
    v_mfma_f32_16x16x32_bf16 v[16:19], v[124:127], v[60:63], v[16:19]
    s_waitcnt lgkmcnt(5)
    v_mfma_f32_16x16x32_bf16 v[16:19], v[128:131], v[64:67], v[16:19]
    s_waitcnt lgkmcnt(4)
    v_mfma_f32_16x16x32_bf16 v[16:19], v[132:135], v[68:71], v[16:19]
    s_waitcnt lgkmcnt(3)
    v_mfma_f32_16x16x32_bf16 v[16:19], v[136:139], v[104:107], v[16:19]
    s_waitcnt lgkmcnt(2)
    v_mfma_f32_16x16x32_bf16 v[16:19], v[140:143], v[108:111], v[16:19]
    s_waitcnt lgkmcnt(1)
    v_mfma_f32_16x16x32_bf16 v[16:19], v[144:147], v[112:115], v[16:19]
    s_waitcnt lgkmcnt(0)
    v_mfma_f32_16x16x32_bf16 v[16:19], v[148:151], v[116:119], v[16:19]
    v_lshl_add_u32 v7, v5, 3, v7
    v_lshl_add_u32 v7, v6, 8, v7
    s_lshl_b32 s3, s64, 9
    s_add_u32 s3, s3, 1024
    s_mov_b32 s64, 0x4b800000
A_kvst:
    s_add_u32 s3, s3, s65
    s_nop 1
    v_mul_f32 v16, s64, v16
    v_mul_f32 v17, s64, v17
    v_mul_f32 v18, s64, v18
    v_mul_f32 v19, s64, v19
    v_cvt_pk_bf16_f32 v10, v16, v17
    v_cvt_pk_bf16_f32 v11, v18, v19
    v_mov_b32 v16, v10
    v_mov_b32 v17, v11
    v_xor_b32 v18, v23, v10
    v_xor_b32 v19, v23, v11
    buffer_store_dwordx4 v[16:19], v2, s[44:47], s15 offen
    buffer_store_dwordx2 v[10:11], v7, s[44:47], s3 offen sc1
    s_setprio 2
    s_mov_b32 s0, 3
    s_nop 1
M_setup:
    s_mov_b32 s44, s26
    s_and_b32 s45, s27, 0xffff
    s_mov_b32 s46, 10616832
    s_mov_b32 s47, 0x00020000
    s_mov_b32 s56, 0x3f803f80
    s_mov_b32 s57, 0xffff0000
    v_and_b32 v154, 15, v1
    v_lshrrev_b32 v155, 4, v1
    v_lshrrev_b32 v157, 5, v1
    v_and_b32 v156, 31, v1
    v_bfe_u32 v16, v1, 2, 2
    v_bfe_u32 v17, v1, 4, 1
    v_lshlrev_b32 v12, 5, v17
    v_and_b32 v17, 3, v1
    v_lshl_add_u32 v12, v17, 3, v12
    v_lshl_add_u32 v158, v16, 7, v12
    v_lshrrev_b32 v15, 1, v16
    v_lshl_add_u32 v158, v15, 6, v158
    v_lshl_add_u32 v158, v157, 9, v158
    s_cmp_eq_u32 s0, 1
    s_cbranch_scc1 N_start
    s_lshr_b32 s62, s54, 2
    s_xor_b32 s62, s62, 1
    s_lshr_b32 s61, s53, 2
    s_xor_b32 s61, s61, s62
    s_lshl_b32 s63, s52, 1
    s_add_u32 s63, s63, s61
    s_lshl_b32 s3, s63, 5
    s_lshl_b32 s69, s53, 2
    s_add_u32 s3, s3, s69
    s_add_u32 s3, s3, s60
    s_lshl_b32 s69, s3, 10
    s_add_u32 s68, s69, 262144
    s_add_u32 s69, s69, 2359296
    v_lshl_add_u32 v8, v155, 3, v16
    v_lshlrev_b32 v8, 7, v8
    v_lshl_add_u32 v8, v17, 3, v8
    v_and_b32 v14, 1, v155
    v_lshl_or_b32 v14, v14, 1, v15
    v_xor_b32 v14, s60, v14
    v_lshl_add_u32 v8, v14, 5, v8
    v_xor_b32 v9, v154, v155
    v_lshlrev_b32 v9, 4, v9
    v_lshl_add_u32 v9, v154, 8, v9
    s_lshr_b32 s3, s53, 2
    s_lshl_b32 s3, s3, 13
    s_add_u32 s3, s3, 65536
    v_add_u32 v162, s3, v9
    v_xor_b32 v163, 64, v162
    v_xor_b32 v164, 128, v162
    v_xor_b32 v165, 192, v162
    v_lshlrev_b32 v3, 4, v154
    v_lshl_add_u32 v3, v157, 8, v3
    v_add_u32 v3, 1024, v3
    v_and_b32 v17, 27, v1
    v_cmp_eq_u32 vcc, 16, v17
    v_mov_b32 v17, 0x4b804b80
    v_mov_b32 v72, 0
    v_cndmask_b32 v88, 0, v17, vcc
    v_mov_b32 v73, 0
    v_mov_b32 v89, v88
    v_mov_b32 v166, v152
    s_lshl_b32 s3, s60, 4
    v_add_u32 v160, s3, v152
    s_lshl_b32 s3, s60, 10
    s_add_u32 s3, s3, 155648
    v_add_u32 v11, s3, v2
    s_mov_b32 s66, 0x0000ffff
    s_mov_b32 s67, 0x0000ffff
    s_lshl_b32 s58, s52, 3
    s_add_u32 s58, s58, s54
    s_lshl_b32 s58, s58, 13
    v_lshlrev_b32 v10, 4, v20
    s_lshl_b32 s3, s53, 7
    v_add_u32 v10, s3, v10
    v_lshl_add_u32 v167, v22, 10, v10
    s_mov_b32 s40, s22
    s_and_b32 s41, s23, 0xffff
    s_mov_b32 s42, 1024
    s_mov_b32 s43, 0x00020000
    v_pk_mov_b32 v[74:75], v[72:73], v[72:73]
    v_pk_mov_b32 v[76:77], v[72:73], v[72:73]
    v_pk_mov_b32 v[78:79], v[72:73], v[72:73]
    v_pk_mov_b32 v[80:81], v[72:73], v[72:73]
    v_pk_mov_b32 v[82:83], v[72:73], v[72:73]
    v_pk_mov_b32 v[84:85], v[72:73], v[72:73]
    v_pk_mov_b32 v[86:87], v[72:73], v[72:73]
    v_pk_mov_b32 v[90:91], v[88:89], v[88:89]
    v_pk_mov_b32 v[92:93], v[88:89], v[88:89]
    v_pk_mov_b32 v[94:95], v[88:89], v[88:89]
    v_pk_mov_b32 v[96:97], v[88:89], v[88:89]
    v_pk_mov_b32 v[98:99], v[88:89], v[88:89]
    v_pk_mov_b32 v[100:101], v[88:89], v[88:89]
    v_pk_mov_b32 v[102:103], v[88:89], v[88:89]
    s_cmp_eq_u32 s0, 2
    s_cbranch_scc1 A_old
    s_cmp_eq_u32 s0, 3
    s_cbranch_scc1 A_qw
N_start:
    v_xor_b32 v20, v20, v22
    v_lshlrev_b32 v20, 4, v20
    v_lshl_add_u32 v20, v22, 8, v20
    s_and_b32 s3, s59, 1
    s_lshl_b32 s3, s3, 7
    s_lshl_b32 s64, s59, 11
    s_add_u32 s3, s3, s64
    s_add_u32 s3, s3, 65536
    v_add_u32 v20, s3, v20
    v_xor_b32 v21, 128, v20
    v_mov_b32 v24, 0
    v_mov_b32 v25, 0
    s_waitcnt vmcnt(7)
    v_dot2_f32_bf16 v24, v120, s56, v24
    v_dot2_f32_bf16 v25, v120, v120, v25
    v_dot2_f32_bf16 v24, v121, s56, v24
    v_dot2_f32_bf16 v25, v121, v121, v25
    v_dot2_f32_bf16 v24, v122, s56, v24
    v_dot2_f32_bf16 v25, v122, v122, v25
    v_dot2_f32_bf16 v24, v123, s56, v24
    v_dot2_f32_bf16 v25, v123, v123, v25
    s_waitcnt vmcnt(6)
    v_dot2_f32_bf16 v24, v124, s56, v24
    v_dot2_f32_bf16 v25, v124, v124, v25
    v_dot2_f32_bf16 v24, v125, s56, v24
    v_dot2_f32_bf16 v25, v125, v125, v25
    v_dot2_f32_bf16 v24, v126, s56, v24
    v_dot2_f32_bf16 v25, v126, v126, v25
    v_dot2_f32_bf16 v24, v127, s56, v24
    v_dot2_f32_bf16 v25, v127, v127, v25
    s_waitcnt vmcnt(5)
    v_dot2_f32_bf16 v24, v128, s56, v24
    v_dot2_f32_bf16 v25, v128, v128, v25
    v_dot2_f32_bf16 v24, v129, s56, v24
    v_dot2_f32_bf16 v25, v129, v129, v25
    v_dot2_f32_bf16 v24, v130, s56, v24
    v_dot2_f32_bf16 v25, v130, v130, v25
    v_dot2_f32_bf16 v24, v131, s56, v24
    v_dot2_f32_bf16 v25, v131, v131, v25
    s_waitcnt vmcnt(4)
    v_dot2_f32_bf16 v24, v132, s56, v24
    v_dot2_f32_bf16 v25, v132, v132, v25
    v_dot2_f32_bf16 v24, v133, s56, v24
    v_dot2_f32_bf16 v25, v133, v133, v25
    v_dot2_f32_bf16 v24, v134, s56, v24
    v_dot2_f32_bf16 v25, v134, v134, v25
    v_dot2_f32_bf16 v24, v135, s56, v24
    v_dot2_f32_bf16 v25, v135, v135, v25
    s_waitcnt vmcnt(3)
    v_dot2_f32_bf16 v24, v136, s56, v24
    v_dot2_f32_bf16 v25, v136, v136, v25
    v_dot2_f32_bf16 v24, v137, s56, v24
    v_dot2_f32_bf16 v25, v137, v137, v25
    v_dot2_f32_bf16 v24, v138, s56, v24
    v_dot2_f32_bf16 v25, v138, v138, v25
    v_dot2_f32_bf16 v24, v139, s56, v24
    v_dot2_f32_bf16 v25, v139, v139, v25
    s_waitcnt vmcnt(2)
    v_dot2_f32_bf16 v24, v140, s56, v24
    v_dot2_f32_bf16 v25, v140, v140, v25
    v_dot2_f32_bf16 v24, v141, s56, v24
    v_dot2_f32_bf16 v25, v141, v141, v25
    v_dot2_f32_bf16 v24, v142, s56, v24
    v_dot2_f32_bf16 v25, v142, v142, v25
    v_dot2_f32_bf16 v24, v143, s56, v24
    v_dot2_f32_bf16 v25, v143, v143, v25
    s_waitcnt vmcnt(1)
    v_dot2_f32_bf16 v24, v144, s56, v24
    v_dot2_f32_bf16 v25, v144, v144, v25
    v_dot2_f32_bf16 v24, v145, s56, v24
    v_dot2_f32_bf16 v25, v145, v145, v25
    v_dot2_f32_bf16 v24, v146, s56, v24
    v_dot2_f32_bf16 v25, v146, v146, v25
    v_dot2_f32_bf16 v24, v147, s56, v24
    v_dot2_f32_bf16 v25, v147, v147, v25
    s_waitcnt vmcnt(0)
    v_dot2_f32_bf16 v24, v148, s56, v24
    v_dot2_f32_bf16 v25, v148, v148, v25
    v_dot2_f32_bf16 v24, v149, s56, v24
    v_dot2_f32_bf16 v25, v149, v149, v25
    v_dot2_f32_bf16 v24, v150, s56, v24
    v_dot2_f32_bf16 v25, v150, v150, v25
    v_dot2_f32_bf16 v24, v151, s56, v24
    v_dot2_f32_bf16 v25, v151, v151, v25
    s_nop 2
    v_add_f32_dpp v24, v24, v24 quad_perm:[1,0,3,2] row_mask:0xf bank_mask:0xf
    v_add_f32_dpp v25, v25, v25 quad_perm:[1,0,3,2] row_mask:0xf bank_mask:0xf
    s_nop 0
    v_add_f32_dpp v24, v24, v24 quad_perm:[2,3,0,1] row_mask:0xf bank_mask:0xf
    v_add_f32_dpp v25, v25, v25 quad_perm:[2,3,0,1] row_mask:0xf bank_mask:0xf
    s_nop 0
    v_add_f32_dpp v24, v24, v24 row_half_mirror row_mask:0xf bank_mask:0xf
    v_add_f32_dpp v25, v25, v25 row_half_mirror row_mask:0xf bank_mask:0xf
    s_nop 0
    v_mul_f32 v24, 0xbb000000, v24
    v_mul_f32 v25, 0x3b000000, v25
    v_fma_f32 v25, -v24, v24, v25
    v_max_f32 v25, 0, v25
    v_add_f32 v25, 0x3727c5ac, v25
    v_rsq_f32 v26, v25
    s_nop 0
    v_cvt_pk_bf16_f32 v26, v26, 0
    v_lshlrev_b32 v27, 16, v26
    v_mul_f32 v24, v24, v27
    v_dot2_f32_bf16 v56, v120, v26, v24
    v_dot2_f32_bf16 v57, v120, v27, v24
    v_dot2_f32_bf16 v58, v121, v26, v24
    v_dot2_f32_bf16 v59, v121, v27, v24
    v_dot2_f32_bf16 v60, v122, v26, v24
    v_dot2_f32_bf16 v61, v122, v27, v24
    v_dot2_f32_bf16 v62, v123, v26, v24
    v_dot2_f32_bf16 v63, v123, v27, v24
    v_cvt_pk_bf16_f32 v120, v56, v57
    v_cvt_pk_bf16_f32 v121, v58, v59
    v_cvt_pk_bf16_f32 v122, v60, v61
    v_cvt_pk_bf16_f32 v123, v62, v63
    ds_write_b128 v20, v[120:123] offset:0
    v_dot2_f32_bf16 v64, v124, v26, v24
    v_dot2_f32_bf16 v65, v124, v27, v24
    v_dot2_f32_bf16 v66, v125, v26, v24
    v_dot2_f32_bf16 v67, v125, v27, v24
    v_dot2_f32_bf16 v68, v126, v26, v24
    v_dot2_f32_bf16 v69, v126, v27, v24
    v_dot2_f32_bf16 v70, v127, v26, v24
    v_dot2_f32_bf16 v71, v127, v27, v24
    v_cvt_pk_bf16_f32 v124, v64, v65
    v_cvt_pk_bf16_f32 v125, v66, v67
    v_cvt_pk_bf16_f32 v126, v68, v69
    v_cvt_pk_bf16_f32 v127, v70, v71
    ds_write_b128 v21, v[124:127] offset:0
    v_dot2_f32_bf16 v56, v128, v26, v24
    v_dot2_f32_bf16 v57, v128, v27, v24
    v_dot2_f32_bf16 v58, v129, v26, v24
    v_dot2_f32_bf16 v59, v129, v27, v24
    v_dot2_f32_bf16 v60, v130, v26, v24
    v_dot2_f32_bf16 v61, v130, v27, v24
    v_dot2_f32_bf16 v62, v131, v26, v24
    v_dot2_f32_bf16 v63, v131, v27, v24
    v_cvt_pk_bf16_f32 v128, v56, v57
    v_cvt_pk_bf16_f32 v129, v58, v59
    v_cvt_pk_bf16_f32 v130, v60, v61
    v_cvt_pk_bf16_f32 v131, v62, v63
    ds_write_b128 v20, v[128:131] offset:16384
    v_dot2_f32_bf16 v64, v132, v26, v24
    v_dot2_f32_bf16 v65, v132, v27, v24
    v_dot2_f32_bf16 v66, v133, v26, v24
    v_dot2_f32_bf16 v67, v133, v27, v24
    v_dot2_f32_bf16 v68, v134, v26, v24
    v_dot2_f32_bf16 v69, v134, v27, v24
    v_dot2_f32_bf16 v70, v135, v26, v24
    v_dot2_f32_bf16 v71, v135, v27, v24
    v_cvt_pk_bf16_f32 v132, v64, v65
    v_cvt_pk_bf16_f32 v133, v66, v67
    v_cvt_pk_bf16_f32 v134, v68, v69
    v_cvt_pk_bf16_f32 v135, v70, v71
    ds_write_b128 v21, v[132:135] offset:16384
    v_dot2_f32_bf16 v56, v136, v26, v24
    v_dot2_f32_bf16 v57, v136, v27, v24
    v_dot2_f32_bf16 v58, v137, v26, v24
    v_dot2_f32_bf16 v59, v137, v27, v24
    v_dot2_f32_bf16 v60, v138, v26, v24
    v_dot2_f32_bf16 v61, v138, v27, v24
    v_dot2_f32_bf16 v62, v139, v26, v24
    v_dot2_f32_bf16 v63, v139, v27, v24
    v_cvt_pk_bf16_f32 v136, v56, v57
    v_cvt_pk_bf16_f32 v137, v58, v59
    v_cvt_pk_bf16_f32 v138, v60, v61
    v_cvt_pk_bf16_f32 v139, v62, v63
    ds_write_b128 v20, v[136:139] offset:32768
    v_dot2_f32_bf16 v64, v140, v26, v24
    v_dot2_f32_bf16 v65, v140, v27, v24
    v_dot2_f32_bf16 v66, v141, v26, v24
    v_dot2_f32_bf16 v67, v141, v27, v24
    v_dot2_f32_bf16 v68, v142, v26, v24
    v_dot2_f32_bf16 v69, v142, v27, v24
    v_dot2_f32_bf16 v70, v143, v26, v24
    v_dot2_f32_bf16 v71, v143, v27, v24
    v_cvt_pk_bf16_f32 v140, v64, v65
    v_cvt_pk_bf16_f32 v141, v66, v67
    v_cvt_pk_bf16_f32 v142, v68, v69
    v_cvt_pk_bf16_f32 v143, v70, v71
    ds_write_b128 v21, v[140:143] offset:32768
    v_dot2_f32_bf16 v56, v144, v26, v24
    v_dot2_f32_bf16 v57, v144, v27, v24
    v_dot2_f32_bf16 v58, v145, v26, v24
    v_dot2_f32_bf16 v59, v145, v27, v24
    v_dot2_f32_bf16 v60, v146, v26, v24
    v_dot2_f32_bf16 v61, v146, v27, v24
    v_dot2_f32_bf16 v62, v147, v26, v24
    v_dot2_f32_bf16 v63, v147, v27, v24
    v_cvt_pk_bf16_f32 v144, v56, v57
    v_cvt_pk_bf16_f32 v145, v58, v59
    v_cvt_pk_bf16_f32 v146, v60, v61
    v_cvt_pk_bf16_f32 v147, v62, v63
    ds_write_b128 v20, v[144:147] offset:49152
    v_dot2_f32_bf16 v64, v148, v26, v24
    v_dot2_f32_bf16 v65, v148, v27, v24
    v_dot2_f32_bf16 v66, v149, v26, v24
    v_dot2_f32_bf16 v67, v149, v27, v24
    v_dot2_f32_bf16 v68, v150, v26, v24
    v_dot2_f32_bf16 v69, v150, v27, v24
    v_dot2_f32_bf16 v70, v151, v26, v24
    v_dot2_f32_bf16 v71, v151, v27, v24
    v_cvt_pk_bf16_f32 v148, v64, v65
    v_cvt_pk_bf16_f32 v149, v66, v67
    v_cvt_pk_bf16_f32 v150, v68, v69
    v_cvt_pk_bf16_f32 v151, v70, v71
    ds_write_b128 v21, v[148:151] offset:49152
    s_waitcnt lgkmcnt(0)
    s_cmp_eq_u32 s0, 1
    s_cbranch_scc0 N_a
    s_mov_b64 exec, 1
    ds_add_u32 v152, v153 offset:96
    s_cmp_ge_u32 s60, 2
    s_cbranch_scc0 G_mm
    ds_add_u32 v152, v153 offset:48
    s_branch G_mm
N_a:
    s_mov_b64 exec, 1
    ds_add_u32 v152, v153 offset:112
    s_mov_b64 exec, -1
    s_lshr_b32 s62, s52, 2
    s_lshl_b32 s62, s62, 2
    s_add_u32 s62, s62, s60
    s_lshl_b32 s59, s62, 13
    s_add_u32 s59, s59, 10354688
    s_add_u32 s64, s59, 4096
    buffer_load_dwordx4 v[32:35], v2, s[44:47], s59 offen offset:0 sc1
    buffer_load_dwordx4 v[36:39], v2, s[44:47], s59 offen offset:1024 sc1
    buffer_load_dwordx4 v[40:43], v2, s[44:47], s59 offen offset:2048 sc1
    buffer_load_dwordx4 v[44:47], v2, s[44:47], s59 offen offset:3072 sc1
    buffer_load_dwordx4 v[48:51], v2, s[44:47], s64 offen offset:0 sc1
    buffer_load_dwordx4 v[52:55], v2, s[44:47], s64 offen offset:1024 sc1
    buffer_load_dwordx4 v[56:59], v2, s[44:47], s64 offen offset:2048 sc1
    buffer_load_dwordx4 v[60:63], v2, s[44:47], s64 offen offset:3072 sc1
    s_lshl_b32 s63, s62, 10
    s_add_u32 s63, s63, 10108928
    s_lshl_b32 s62, s62, 12
    s_lshl_b32 s15, s60, 12
    v_and_b32 v113, 7, v1
    v_lshlrev_b32 v113, 7, v113
    v_and_b32 v20, 1, v155
    v_lshrrev_b32 v21, 1, v155
    v_lshl_add_u32 v23, v154, 4, s15
    v_lshl_add_u32 v22, v20, 3, v23
    v_lshl_add_u32 v22, v21, 9, v22
    v_lshl_add_u32 v23, v20, 3, v23
    v_lshl_add_u32 v23, v21, 8, v23
    s_mov_b32 s1, 0x20000
W_l2:
    ds_read_b32 v161, v152 offset:16
    s_waitcnt lgkmcnt(0)
    v_readfirstlane_b32 s14, v161
    s_cmp_ge_u32 s14, 4
    s_cbranch_scc1 W_o2
    s_sleep 1
    s_branch W_l2
W_o2:
    ds_read2_b32 v[30:31], v152 offset0:44 offset1:44
    s_waitcnt lgkmcnt(0)
    v_readfirstlane_b32 s55, v30
K_chk:
    s_waitcnt vmcnt(7)
    v_xor_b32 v34, v32, v34
    v_xor_b32 v35, v33, v35
    v_cmp_ne_u64 vcc, v[34:35], v[30:31]
    s_waitcnt vmcnt(6)
    v_xor_b32 v38, v36, v38
    v_xor_b32 v39, v37, v39
    v_cmp_ne_u64 s[8:9], v[38:39], v[30:31]
    s_or_b64 vcc, vcc, s[8:9]
    s_waitcnt vmcnt(5)
    v_xor_b32 v42, v40, v42
    v_xor_b32 v43, v41, v43
    v_cmp_ne_u64 s[8:9], v[42:43], v[30:31]
    s_or_b64 vcc, vcc, s[8:9]
    s_waitcnt vmcnt(4)
    v_xor_b32 v46, v44, v46
    v_xor_b32 v47, v45, v47
    v_cmp_ne_u64 s[8:9], v[46:47], v[30:31]
    s_or_b64 vcc, vcc, s[8:9]
    s_waitcnt vmcnt(3)
    v_xor_b32 v50, v48, v50
    v_xor_b32 v51, v49, v51
    v_cmp_ne_u64 s[8:9], v[50:51], v[30:31]
    s_or_b64 vcc, vcc, s[8:9]
    s_waitcnt vmcnt(2)
    v_xor_b32 v54, v52, v54
    v_xor_b32 v55, v53, v55
    v_cmp_ne_u64 s[8:9], v[54:55], v[30:31]
    s_or_b64 vcc, vcc, s[8:9]
    s_waitcnt vmcnt(1)
    v_xor_b32 v58, v56, v58
    v_xor_b32 v59, v57, v59
    v_cmp_ne_u64 s[8:9], v[58:59], v[30:31]
    s_or_b64 vcc, vcc, s[8:9]
    s_waitcnt vmcnt(0)
    v_xor_b32 v62, v60, v62
    v_xor_b32 v63, v61, v63
    v_cmp_ne_u64 s[8:9], v[62:63], v[30:31]
    s_or_b64 vcc, vcc, s[8:9]
    s_cbranch_vccnz K_not
    ds_write_b64 v22, v[32:33] offset:0
    ds_write_b64 v23, v[36:37] offset:1024
    ds_write_b64 v22, v[40:41] offset:256
    ds_write_b64 v23, v[44:45] offset:1536
    ds_write_b64 v22, v[48:49] offset:2048
    ds_write_b64 v23, v[52:53] offset:3072
    ds_write_b64 v22, v[56:57] offset:2304
    ds_write_b64 v23, v[60:61] offset:3584
K_done:
    s_mov_b64 exec, 3
    ds_add_u32 v152, v153 offset:256
    s_mov_b64 exec, -1
W_l3:
    ds_read_b32 v161, v160 offset:192
    s_waitcnt lgkmcnt(0)
    v_readfirstlane_b32 s14, v161
    s_cmp_ge_u32 s14, 1
    s_cbranch_scc1 W_o3
    s_sleep 1
    s_branch W_l3
W_o3:
    ds_read_b128 v[4:7], v11
    s_branch A_q2
A_qw:
W_l4:
    ds_read_b32 v161, v152 offset:80
    s_waitcnt lgkmcnt(0)
    v_readfirstlane_b32 s14, v161
    s_cmp_ge_u32 s14, 2
    s_cbranch_scc1 W_o4
    s_sleep 1
    s_branch W_l4
W_o4:
    ds_read_b64_tr_b16 v[24:25], v8 offset:0
    ds_read_b64_tr_b16 v[26:27], v8 offset:512
    ds_read_b64_tr_b16 v[28:29], v8 offset:4096
    ds_read_b64_tr_b16 v[30:31], v8 offset:4608
    ds_read_b64_tr_b16 v[32:33], v8 offset:8192
    ds_read_b64_tr_b16 v[34:35], v8 offset:8704
    ds_read_b64_tr_b16 v[36:37], v8 offset:12288
    ds_read_b64_tr_b16 v[38:39], v8 offset:12800
    ds_read_b64_tr_b16 v[40:41], v8 offset:16384
    ds_read_b64_tr_b16 v[42:43], v8 offset:16896
    ds_read_b64_tr_b16 v[44:45], v8 offset:20480
    ds_read_b64_tr_b16 v[46:47], v8 offset:20992
    ds_read_b64_tr_b16 v[48:49], v8 offset:24576
    ds_read_b64_tr_b16 v[50:51], v8 offset:25088
    ds_read_b64_tr_b16 v[52:53], v8 offset:28672
    ds_read_b64_tr_b16 v[54:55], v8 offset:29184
    ds_read_b64_tr_b16 v[56:57], v8 offset:32768
    ds_read_b64_tr_b16 v[58:59], v8 offset:33280
    ds_read_b64_tr_b16 v[60:61], v8 offset:36864
    ds_read_b64_tr_b16 v[62:63], v8 offset:37376
    ds_read_b64_tr_b16 v[64:65], v8 offset:40960
    ds_read_b64_tr_b16 v[66:67], v8 offset:41472
    ds_read_b64_tr_b16 v[68:69], v8 offset:45056
    ds_read_b64_tr_b16 v[70:71], v8 offset:45568
    ds_read_b64_tr_b16 v[104:105], v8 offset:49152
    ds_read_b64_tr_b16 v[106:107], v8 offset:49664
    ds_read_b64_tr_b16 v[108:109], v8 offset:53248
    ds_read_b64_tr_b16 v[110:111], v8 offset:53760
    ds_read_b64_tr_b16 v[112:113], v8 offset:57344
    ds_read_b64_tr_b16 v[114:115], v8 offset:57856
    ds_read_b64_tr_b16 v[116:117], v8 offset:61440
    ds_read_b64_tr_b16 v[118:119], v8 offset:61952
    s_mov_b64 exec, 1
    ds_add_u32 v152, v153 offset:16
    s_mov_b64 exec, -1
    s_mov_b32 s65, 0
A_q:
W_l5:
    ds_read_b32 v161, v166 offset:96
    s_waitcnt lgkmcnt(0)
    v_readfirstlane_b32 s14, v161
    s_cmp_ge_u32 s14, 4
    s_cbranch_scc1 W_o5
    s_sleep 1
    s_branch W_l5
W_o5:
    ds_read_b128 v[120:123], v162 offset:0
    ds_read_b128 v[124:127], v162 offset:4096
    ds_read_b128 v[128:131], v163 offset:0
    ds_read_b128 v[132:135], v163 offset:4096
    ds_read_b128 v[136:139], v164 offset:0
    ds_read_b128 v[140:143], v164 offset:4096
    ds_read_b128 v[144:147], v165 offset:0
    ds_read_b128 v[148:151], v165 offset:4096
    s_waitcnt lgkmcnt(6)
    v_mfma_f32_16x16x32_bf16 v[12:15], v[24:27], v[120:123], 0
    v_mfma_f32_16x16x32_bf16 v[16:19], v[24:27], v[124:127], 0
    ds_read_b128 v[120:123], v162 offset:16384
    ds_read_b128 v[124:127], v162 offset:20480
    s_waitcnt lgkmcnt(6)
    v_mfma_f32_16x16x32_bf16 v[12:15], v[28:31], v[128:131], v[12:15]
    v_mfma_f32_16x16x32_bf16 v[16:19], v[28:31], v[132:135], v[16:19]
    ds_read_b128 v[128:131], v163 offset:16384
    ds_read_b128 v[132:135], v163 offset:20480
    s_waitcnt lgkmcnt(6)
    v_mfma_f32_16x16x32_bf16 v[12:15], v[32:35], v[136:139], v[12:15]
    v_mfma_f32_16x16x32_bf16 v[16:19], v[32:35], v[140:143], v[16:19]
    ds_read_b128 v[136:139], v164 offset:16384
    ds_read_b128 v[140:143], v164 offset:20480
    s_waitcnt lgkmcnt(6)
    v_mfma_f32_16x16x32_bf16 v[12:15], v[36:39], v[144:147], v[12:15]
    v_mfma_f32_16x16x32_bf16 v[16:19], v[36:39], v[148:151], v[16:19]
    ds_read_b128 v[144:147], v165 offset:16384
    ds_read_b128 v[148:151], v165 offset:20480
    s_waitcnt lgkmcnt(6)
    v_mfma_f32_16x16x32_bf16 v[12:15], v[40:43], v[120:123], v[12:15]
    v_mfma_f32_16x16x32_bf16 v[16:19], v[40:43], v[124:127], v[16:19]
    ds_read_b128 v[120:123], v162 offset:32768
    ds_read_b128 v[124:127], v162 offset:36864
    s_waitcnt lgkmcnt(6)
    v_mfma_f32_16x16x32_bf16 v[12:15], v[44:47], v[128:131], v[12:15]
    v_mfma_f32_16x16x32_bf16 v[16:19], v[44:47], v[132:135], v[16:19]
    ds_read_b128 v[128:131], v163 offset:32768
    ds_read_b128 v[132:135], v163 offset:36864
    s_waitcnt lgkmcnt(6)
    v_mfma_f32_16x16x32_bf16 v[12:15], v[48:51], v[136:139], v[12:15]
    v_mfma_f32_16x16x32_bf16 v[16:19], v[48:51], v[140:143], v[16:19]
    ds_read_b128 v[136:139], v164 offset:32768
    ds_read_b128 v[140:143], v164 offset:36864
    s_cmp_eq_u32 s0, 3
    s_cbranch_scc1 A_fl
A_flr:
    s_waitcnt lgkmcnt(6)
    v_mfma_f32_16x16x32_bf16 v[12:15], v[52:55], v[144:147], v[12:15]
    v_mfma_f32_16x16x32_bf16 v[16:19], v[52:55], v[148:151], v[16:19]
    ds_read_b128 v[144:147], v165 offset:32768
    ds_read_b128 v[148:151], v165 offset:36864
    s_waitcnt lgkmcnt(6)
    v_mfma_f32_16x16x32_bf16 v[12:15], v[56:59], v[120:123], v[12:15]
    v_mfma_f32_16x16x32_bf16 v[16:19], v[56:59], v[124:127], v[16:19]
    ds_read_b128 v[120:123], v162 offset:49152
    ds_read_b128 v[124:127], v162 offset:53248
    s_waitcnt lgkmcnt(6)
    v_mfma_f32_16x16x32_bf16 v[12:15], v[60:63], v[128:131], v[12:15]
    v_mfma_f32_16x16x32_bf16 v[16:19], v[60:63], v[132:135], v[16:19]
    ds_read_b128 v[128:131], v163 offset:49152
    ds_read_b128 v[132:135], v163 offset:53248
    s_waitcnt lgkmcnt(6)
    v_mfma_f32_16x16x32_bf16 v[12:15], v[64:67], v[136:139], v[12:15]
    v_mfma_f32_16x16x32_bf16 v[16:19], v[64:67], v[140:143], v[16:19]
    ds_read_b128 v[136:139], v164 offset:49152
    ds_read_b128 v[140:143], v164 offset:53248
    s_waitcnt lgkmcnt(6)
    v_mfma_f32_16x16x32_bf16 v[12:15], v[68:71], v[144:147], v[12:15]
    v_mfma_f32_16x16x32_bf16 v[16:19], v[68:71], v[148:151], v[16:19]
    ds_read_b128 v[144:147], v165 offset:49152
    ds_read_b128 v[148:151], v165 offset:53248
    s_waitcnt lgkmcnt(6)
    v_mfma_f32_16x16x32_bf16 v[12:15], v[104:107], v[120:123], v[12:15]
    v_mfma_f32_16x16x32_bf16 v[16:19], v[104:107], v[124:127], v[16:19]
    s_waitcnt lgkmcnt(4)
    v_mfma_f32_16x16x32_bf16 v[12:15], v[108:111], v[128:131], v[12:15]
    v_mfma_f32_16x16x32_bf16 v[16:19], v[108:111], v[132:135], v[16:19]
    s_waitcnt lgkmcnt(2)
    v_mfma_f32_16x16x32_bf16 v[12:15], v[112:115], v[136:139], v[12:15]
    v_mfma_f32_16x16x32_bf16 v[16:19], v[112:115], v[140:143], v[16:19]
    s_waitcnt lgkmcnt(0)
    v_mfma_f32_16x16x32_bf16 v[12:15], v[116:119], v[144:147], v[12:15]
    v_mfma_f32_16x16x32_bf16 v[16:19], v[116:119], v[148:151], v[16:19]
    s_mov_b32 s3, 0x3eb8aa3b
    v_xor_b32 v162, 8192, v162
    v_xor_b32 v163, 8192, v163
    v_xor_b32 v164, 8192, v164
    v_xor_b32 v165, 8192, v165
    v_add_u32 v166, 16, v166
    s_nop 1
    v_mul_f32 v12, s3, v12
    v_mul_f32 v13, s3, v13
    v_mul_f32 v14, s3, v14
    v_mul_f32 v15, s3, v15
    v_mul_f32 v16, s3, v16
    v_mul_f32 v17, s3, v17
    v_mul_f32 v18, s3, v18
    v_mul_f32 v19, s3, v19
    v_cvt_pk_bf16_f32 v4, v12, v13
    v_cvt_pk_bf16_f32 v5, v14, v15
    v_cvt_pk_bf16_f32 v6, v16, v17
    v_cvt_pk_bf16_f32 v7, v18, v19
    s_nop 1
    v_permlane16_swap_b32 v4, v6
    v_permlane16_swap_b32 v5, v7
    s_cmp_lg_u32 s65, 0
    s_cbranch_scc1 A_q2
    s_mov_b32 s65, 1
    ds_write_b128 v11, v[4:7]
    s_mov_b64 exec, 1
    ds_add_u32 v160, v153 offset:192
    s_mov_b64 exec, -1
    s_branch A_q
A_fl:
    s_mov_b32 s0, 2
    s_mov_b64 exec, 1
    s_waitcnt vmcnt(0)
    buffer_store_dword v23, v159, s[44:47], s59 offen sc1
    ds_add_u32 v152, v153 offset:144
    s_mov_b64 exec, -1
    s_branch A_flr
A_q2:
    s_mov_b64 exec, 1
    ds_add_u32 v152, v153 offset:512
    s_mov_b64 exec, -1
A_go:
    v_mov_b32 v162, v2
    v_mov_b32 v163, v3
    buffer_load_dwordx4 v[104:107], v167, s[28:31], s58 offen
    buffer_load_dwordx4 v[108:111], v10, s[40:43], 0 offen
    s_mov_b32 s65, 2
    s_mov_b32 s64, 1
    v_mov_b32 v48, 0
    v_mov_b32 v49, 0
    v_mov_b32 v50, 0
    v_mov_b32 v51, 0
    v_mov_b32 v52, 0
    v_mov_b32 v53, 0
    v_mov_b32 v54, 0
    v_mov_b32 v55, 0
    v_mov_b32 v20, 0xdddddddd
W_l6:
    ds_read_b32 v161, v152 offset:256
    s_waitcnt lgkmcnt(0)
    v_readfirstlane_b32 s14, v161
    s_cmp_ge_u32 s14, 8
    s_cbranch_scc1 W_o6
    s_sleep 1
    s_branch W_l6
W_o6:
    ds_read_b128 v[8:11], v162
    ds_read_b128 v[12:15], v162 offset:2048
    s_mov_b64 exec, s[66:67]
    ds_read_b128 v[88:91], v163
    ds_read_b128 v[92:95], v163 offset:512
    s_mov_b64 exec, -1
    s_waitcnt lgkmcnt(3)
    v_mfma_f32_32x32x16_bf16 v[24:39], v[8:11], v[4:7], 0
    s_cmp_ge_u32 s54, 4
    s_cselect_b64 vcc, -1, 0
    s_nop 9
    v_max3_f32 v160, v24, v25, v26
    v_max3_f32 v160, v160, v27, v28
    v_max3_f32 v160, v160, v29, v30
    v_max3_f32 v160, v160, v31, v32
    v_max3_f32 v160, v160, v33, v34
    v_max3_f32 v160, v160, v35, v36
    v_max3_f32 v160, v160, v37, v38
    v_max_f32 v160, v160, v39
    v_mov_b32 v161, v160
    s_nop 1
    v_permlane32_swap_b32 v160, v161
    v_max_f32 v160, v160, v161
    v_sub_f32 v56, 0xc2d00000, v160
    v_mov_b32 v57, v56
    v_pk_add_f32 v[24:25], v[24:25], v[56:57]
    v_pk_add_f32 v[26:27], v[26:27], v[56:57]
    v_pk_add_f32 v[28:29], v[28:29], v[56:57]
    v_pk_add_f32 v[30:31], v[30:31], v[56:57]
    v_pk_add_f32 v[32:33], v[32:33], v[56:57]
    v_pk_add_f32 v[34:35], v[34:35], v[56:57]
    v_pk_add_f32 v[36:37], v[36:37], v[56:57]
    v_pk_add_f32 v[38:39], v[38:39], v[56:57]
    v_pk_mov_b32 v[58:59], v[56:57], v[56:57]
    v_pk_mov_b32 v[60:61], v[56:57], v[56:57]
    v_pk_mov_b32 v[62:63], v[56:57], v[56:57]
    v_pk_mov_b32 v[64:65], v[56:57], v[56:57]
    v_pk_mov_b32 v[66:67], v[56:57], v[56:57]
    v_pk_mov_b32 v[68:69], v[56:57], v[56:57]
    v_pk_mov_b32 v[70:71], v[56:57], v[56:57]
    s_setprio 0
    s_mov_b32 s59, 5
.p2align 6
B_loop:
    s_cbranch_vccz B_sp7
    s_setprio 1
B_sp7:
    v_exp_f32 v24, v24
    v_exp_f32 v25, v25
    v_smfmac_f32_32x32x32_bf16 v[72:87], v[100:103], v[48:55], v20
    v_exp_f32 v26, v26
    v_exp_f32 v27, v27
    s_waitcnt lgkmcnt(0)
    s_mov_b64 exec, s[66:67]
    ds_read_b128 v[96:99], v163 offset:2048
    ds_read_b128 v[100:103], v163 offset:2560
    s_mov_b64 exec, -1
    v_exp_f32 v28, v28
    v_exp_f32 v29, v29
    v_mfma_f32_32x32x16_bf16 v[40:55], v[12:15], v[4:7], v[56:71]
    ds_read_b128 v[8:11], v162 offset:4096
    v_exp_f32 v30, v30
    v_exp_f32 v31, v31
    v_exp_f32 v32, v32
    v_exp_f32 v33, v33
    v_smfmac_f32_32x32x32_bf16 v[72:87], v[88:91], v[24:31], v20
    v_exp_f32 v34, v34
    v_exp_f32 v35, v35
    v_exp_f32 v36, v36
    v_exp_f32 v37, v37
    v_exp_f32 v38, v38
    v_exp_f32 v39, v39
    v_exp_f32 v40, v40
    v_exp_f32 v41, v41
    v_smfmac_f32_32x32x32_bf16 v[72:87], v[92:95], v[32:39], v20
    v_exp_f32 v42, v42
    v_exp_f32 v43, v43
    s_waitcnt lgkmcnt(0)
    s_mov_b64 exec, s[66:67]
    ds_read_b128 v[88:91], v163 offset:4096
    ds_read_b128 v[92:95], v163 offset:4608
    s_mov_b64 exec, -1
    v_exp_f32 v44, v44
    v_exp_f32 v45, v45
    v_mfma_f32_32x32x16_bf16 v[24:39], v[8:11], v[4:7], v[56:71]
    ds_read_b128 v[12:15], v162 offset:6144
    v_exp_f32 v46, v46
    v_exp_f32 v47, v47
    v_exp_f32 v48, v48
    v_exp_f32 v49, v49
    v_smfmac_f32_32x32x32_bf16 v[72:87], v[96:99], v[40:47], v20
    v_exp_f32 v50, v50
    v_exp_f32 v51, v51
    v_exp_f32 v52, v52
    v_exp_f32 v53, v53
    v_exp_f32 v54, v54
    v_exp_f32 v55, v55
    v_exp_f32 v24, v24
    v_exp_f32 v25, v25
    v_smfmac_f32_32x32x32_bf16 v[72:87], v[100:103], v[48:55], v20
    v_exp_f32 v26, v26
    v_exp_f32 v27, v27
    s_waitcnt lgkmcnt(0)
    s_mov_b64 exec, s[66:67]
    ds_read_b128 v[96:99], v163 offset:6144
    ds_read_b128 v[100:103], v163 offset:6656
    s_mov_b64 exec, -1
    v_exp_f32 v28, v28
    v_exp_f32 v29, v29
    v_mfma_f32_32x32x16_bf16 v[40:55], v[12:15], v[4:7], v[56:71]
    ds_read_b128 v[8:11], v162 offset:8192
    v_exp_f32 v30, v30
    v_exp_f32 v31, v31
    v_exp_f32 v32, v32
    v_exp_f32 v33, v33
    v_smfmac_f32_32x32x32_bf16 v[72:87], v[88:91], v[24:31], v20
    v_exp_f32 v34, v34
    v_exp_f32 v35, v35
    v_exp_f32 v36, v36
    v_exp_f32 v37, v37
    v_exp_f32 v38, v38
    v_exp_f32 v39, v39
    v_exp_f32 v40, v40
    v_exp_f32 v41, v41
    v_smfmac_f32_32x32x32_bf16 v[72:87], v[92:95], v[32:39], v20
    v_exp_f32 v42, v42
    v_exp_f32 v43, v43
    s_waitcnt lgkmcnt(0)
    s_mov_b64 exec, s[66:67]
    ds_read_b128 v[88:91], v163 offset:8192
    ds_read_b128 v[92:95], v163 offset:8704
    s_mov_b64 exec, -1
    v_exp_f32 v44, v44
    v_exp_f32 v45, v45
    v_mfma_f32_32x32x16_bf16 v[24:39], v[8:11], v[4:7], v[56:71]
    ds_read_b128 v[12:15], v162 offset:10240
    v_exp_f32 v46, v46
    v_exp_f32 v47, v47
    v_exp_f32 v48, v48
    v_exp_f32 v49, v49
    v_smfmac_f32_32x32x32_bf16 v[72:87], v[96:99], v[40:47], v20
    v_exp_f32 v50, v50
    v_exp_f32 v51, v51
    v_exp_f32 v52, v52
    v_exp_f32 v53, v53
    v_exp_f32 v54, v54
    v_exp_f32 v55, v55
    v_exp_f32 v24, v24
    v_exp_f32 v25, v25
    v_smfmac_f32_32x32x32_bf16 v[72:87], v[100:103], v[48:55], v20
    v_exp_f32 v26, v26
    v_exp_f32 v27, v27
    s_waitcnt lgkmcnt(0)
    s_mov_b64 exec, s[66:67]
    ds_read_b128 v[96:99], v163 offset:10240
    ds_read_b128 v[100:103], v163 offset:10752
    s_mov_b64 exec, -1
    v_exp_f32 v28, v28
    v_exp_f32 v29, v29
    v_mfma_f32_32x32x16_bf16 v[40:55], v[12:15], v[4:7], v[56:71]
    ds_read_b128 v[8:11], v162 offset:12288
    v_exp_f32 v30, v30
    v_exp_f32 v31, v31
    v_exp_f32 v32, v32
    v_exp_f32 v33, v33
    v_smfmac_f32_32x32x32_bf16 v[72:87], v[88:91], v[24:31], v20
    v_exp_f32 v34, v34
    v_exp_f32 v35, v35
    v_exp_f32 v36, v36
    v_exp_f32 v37, v37
    v_exp_f32 v38, v38
    v_exp_f32 v39, v39
    v_exp_f32 v40, v40
    v_exp_f32 v41, v41
    v_smfmac_f32_32x32x32_bf16 v[72:87], v[92:95], v[32:39], v20
    v_exp_f32 v42, v42
    v_exp_f32 v43, v43
    s_waitcnt lgkmcnt(0)
    s_mov_b64 exec, s[66:67]
    ds_read_b128 v[88:91], v163 offset:12288
    ds_read_b128 v[92:95], v163 offset:12800
    s_mov_b64 exec, -1
    v_exp_f32 v44, v44
    v_exp_f32 v45, v45
    v_mfma_f32_32x32x16_bf16 v[24:39], v[8:11], v[4:7], v[56:71]
    ds_read_b128 v[12:15], v162 offset:14336
    v_exp_f32 v46, v46
    v_exp_f32 v47, v47
    v_exp_f32 v48, v48
    v_exp_f32 v49, v49
    v_smfmac_f32_32x32x32_bf16 v[72:87], v[96:99], v[40:47], v20
    v_exp_f32 v50, v50
    v_exp_f32 v51, v51
    v_exp_f32 v52, v52
    v_exp_f32 v53, v53
    v_exp_f32 v54, v54
    v_exp_f32 v55, v55
    s_cbranch_vccz B_sp8
    s_setprio 0
B_sp8:
    s_cmp_lt_u32 s64, s65
    s_cbranch_scc1 B_need
B_have:
    v_exp_f32 v24, v24
    v_exp_f32 v25, v25
    v_smfmac_f32_32x32x32_bf16 v[72:87], v[100:103], v[48:55], v20
    v_exp_f32 v26, v26
    v_exp_f32 v27, v27
    s_waitcnt lgkmcnt(0)
    s_mov_b64 exec, s[66:67]
    ds_read_b128 v[96:99], v163 offset:14336
    ds_read_b128 v[100:103], v163 offset:14848
    s_mov_b64 exec, -1
    v_exp_f32 v28, v28
    v_exp_f32 v29, v29
    v_mfma_f32_32x32x16_bf16 v[40:55], v[12:15], v[4:7], v[56:71]
    ds_read_b128 v[8:11], v162 offset:16384
    v_exp_f32 v30, v30
    v_exp_f32 v31, v31
    v_exp_f32 v32, v32
    v_exp_f32 v33, v33
    v_smfmac_f32_32x32x32_bf16 v[72:87], v[88:91], v[24:31], v20
    v_exp_f32 v34, v34
    v_exp_f32 v35, v35
    v_exp_f32 v36, v36
    v_exp_f32 v37, v37
    v_exp_f32 v38, v38
    v_exp_f32 v39, v39
    v_exp_f32 v40, v40
    v_exp_f32 v41, v41
    v_smfmac_f32_32x32x32_bf16 v[72:87], v[92:95], v[32:39], v20
    v_exp_f32 v42, v42
    v_exp_f32 v43, v43
    s_waitcnt lgkmcnt(0)
    s_mov_b64 exec, s[66:67]
    ds_read_b128 v[88:91], v163 offset:16384
    ds_read_b128 v[92:95], v163 offset:16896
    s_mov_b64 exec, -1
    v_exp_f32 v44, v44
    v_exp_f32 v45, v45
    v_mfma_f32_32x32x16_bf16 v[24:39], v[8:11], v[4:7], v[56:71]
    ds_read_b128 v[12:15], v162 offset:18432
    s_add_u32 s65, s65, 1
    v_exp_f32 v46, v46
    v_exp_f32 v47, v47
    v_exp_f32 v48, v48
    v_exp_f32 v49, v49
    v_smfmac_f32_32x32x32_bf16 v[72:87], v[96:99], v[40:47], v20
    v_add_u32 v162, 16384, v162
    v_add_u32 v163, 16384, v163
    s_cmp_lg_u32 s65, s59
    v_exp_f32 v50, v50
    v_exp_f32 v51, v51
    v_exp_f32 v52, v52
    v_exp_f32 v53, v53
    v_exp_f32 v54, v54
    v_exp_f32 v55, v55
    s_cbranch_scc1 B_loop
    s_cmp_eq_u32 s65, 10
    s_cbranch_scc1 B_post
    s_cmp_eq_u32 s65, 5
    s_cbranch_scc0 B_p2
    s_mov_b32 s59, 6
    s_mov_b64 exec, 1
    ds_add_u32 v152, v153 offset:544
    s_mov_b64 exec, -1
    s_branch B_loop
B_p2:
    s_mov_b32 s59, 10
    s_mov_b64 exec, 1
    ds_add_u32 v152, v153 offset:528
    s_mov_b64 exec, -1
    s_branch B_loop
B_need:
    ds_read_b32 v161, v152 offset:272
    s_waitcnt lgkmcnt(0)
    v_readfirstlane_b32 s64, v161
    s_cmp_ge_u32 s64, s65
    s_cbranch_scc1 B_have
    s_sleep 1
    s_branch B_need
B_post:
    s_setprio 1
    v_smfmac_f32_32x32x32_bf16 v[72:87], v[100:103], v[48:55], v20
    s_mov_b32 s48, s24
    s_and_b32 s49, s25, 0xffff
    s_mov_b32 s50, 2097152
    s_mov_b32 s51, 0x00020000
    s_mov_b32 s3, 0x7b800000
    s_waitcnt vmcnt(0) lgkmcnt(0)
    s_nop 5
    v_rcp_f32 v161, v80
    v_fma_f32 v160, v72, 0, v80
    v_fma_f32 v160, v73, 0, v160
    v_fma_f32 v160, v74, 0, v160
    v_fma_f32 v160, v75, 0, v160
    v_fma_f32 v160, v76, 0, v160
    v_fma_f32 v160, v77, 0, v160
    v_fma_f32 v160, v78, 0, v160
    v_fma_f32 v160, v79, 0, v160
    v_cmp_gt_f32 vcc, s3, v160
    s_cmp_lg_u64 vcc, -1
    s_cbranch_scc1 F_start
B_fin:
    v_mul_f32 v72, v161, v72
    v_mul_f32 v73, v161, v73
    v_mul_f32 v74, v161, v74
    v_mul_f32 v75, v161, v75
    v_mul_f32 v76, v161, v76
    v_mul_f32 v77, v161, v77
    v_mul_f32 v78, v161, v78
    v_mul_f32 v79, v161, v79
    v_cvt_pk_bf16_f32 v16, v72, v73
    v_cvt_pk_bf16_f32 v17, v74, v75
    v_cvt_pk_bf16_f32 v18, v76, v77
    v_cvt_pk_bf16_f32 v19, v78, v79
    v_min_u32 v16, -2, v16
    v_min_u32 v17, -2, v17
    v_min_u32 v18, -2, v18
    v_min_u32 v19, -2, v19
    buffer_store_dwordx4 v[16:19], v2, s[44:47], s69 offen sc1
    s_setprio 0
    s_lshr_b32 s61, s54, 2
    s_lshl_b32 s66, s52, 1
    s_add_u32 s66, s66, s61
    s_lshl_b32 s66, s66, 5
    s_lshl_b32 s3, s60, 3
    s_add_u32 s66, s66, s3
    s_lshl_b32 s66, s66, 10
    s_add_u32 s66, s66, 2359296
    s_add_u32 s62, s66, 4096
    s_mov_b32 s65, 0
    v_and_b32 v4, 7, v1
    v_xor_b32 v20, v4, v157
    v_lshlrev_b32 v4, 1, v4
    v_lshrrev_b32 v5, 3, v1
    v_xor_b32 v4, v4, v5
    v_lshlrev_b32 v4, 4, v4
    v_lshl_add_u32 v4, v5, 8, v4
    s_lshl_b32 s3, s54, 11
    v_add_u32 v4, s3, v4
    v_xor_b32 v5, 16, v4
    v_add_u32 v6, 65536, v4
    v_add_u32 v7, 65536, v5
    v_lshlrev_b32 v20, 4, v20
    v_lshl_add_u32 v20, v156, 8, v20
    s_lshl_b32 s3, s60, 14
    s_lshl_b32 s59, s61, 13
    s_add_u32 s59, s59, s3
    v_add_u32 v20, s59, v20
    v_xor_b32 v21, 32, v20
    v_xor_b32 v22, 64, v20
    v_xor_b32 v23, 96, v20
    v_add_u32 v162, s3, v158
    v_xor_b32 v163, 64, v162
    v_lshlrev_b32 v8, 16, v104
    v_and_b32 v9, s57, v104
    v_lshlrev_b32 v56, 16, v108
    v_and_b32 v57, s57, v108
    v_lshlrev_b32 v10, 16, v105
    v_and_b32 v11, s57, v105
    v_lshlrev_b32 v58, 16, v109
    v_and_b32 v59, s57, v109
    v_lshlrev_b32 v12, 16, v106
    v_and_b32 v13, s57, v106
    v_lshlrev_b32 v60, 16, v110
    v_and_b32 v61, s57, v110
    v_lshlrev_b32 v14, 16, v107
    v_and_b32 v15, s57, v107
    v_lshlrev_b32 v62, 16, v111
    v_and_b32 v63, s57, v111
    v_pk_add_f32 v[8:9], v[8:9], v[56:57]
    v_pk_add_f32 v[10:11], v[10:11], v[58:59]
    v_pk_add_f32 v[12:13], v[12:13], v[60:61]
    v_pk_add_f32 v[14:15], v[14:15], v[62:63]
    s_barrier
    ds_read_b64_tr_b16 v[88:89], v162 offset:0
    ds_read_b64_tr_b16 v[90:91], v162 offset:1024
    ds_read_b64_tr_b16 v[92:93], v163 offset:0
    ds_read_b64_tr_b16 v[94:95], v163 offset:1024
    ds_read_b64_tr_b16 v[96:97], v162 offset:2048
    ds_read_b64_tr_b16 v[98:99], v162 offset:3072
    ds_read_b64_tr_b16 v[100:101], v163 offset:2048
    ds_read_b64_tr_b16 v[102:103], v163 offset:3072
    ds_read_b64_tr_b16 v[104:105], v162 offset:4096
    ds_read_b64_tr_b16 v[106:107], v162 offset:5120
    ds_read_b64_tr_b16 v[108:109], v163 offset:4096
    ds_read_b64_tr_b16 v[110:111], v163 offset:5120
    ds_read_b64_tr_b16 v[112:113], v162 offset:6144
    ds_read_b64_tr_b16 v[114:115], v162 offset:7168
    ds_read_b64_tr_b16 v[116:117], v163 offset:6144
    ds_read_b64_tr_b16 v[118:119], v163 offset:7168
    ds_read_b64_tr_b16 v[120:121], v162 offset:8192
    ds_read_b64_tr_b16 v[122:123], v162 offset:9216
    ds_read_b64_tr_b16 v[124:125], v163 offset:8192
    ds_read_b64_tr_b16 v[126:127], v163 offset:9216
    ds_read_b64_tr_b16 v[128:129], v162 offset:10240
    ds_read_b64_tr_b16 v[130:131], v162 offset:11264
    ds_read_b64_tr_b16 v[132:133], v163 offset:10240
    ds_read_b64_tr_b16 v[134:135], v163 offset:11264
    ds_read_b64_tr_b16 v[136:137], v162 offset:12288
    ds_read_b64_tr_b16 v[138:139], v162 offset:13312
    ds_read_b64_tr_b16 v[140:141], v163 offset:12288
    ds_read_b64_tr_b16 v[142:143], v163 offset:13312
    ds_read_b64_tr_b16 v[144:145], v162 offset:14336
    ds_read_b64_tr_b16 v[146:147], v162 offset:15360
    ds_read_b64_tr_b16 v[148:149], v163 offset:14336
    ds_read_b64_tr_b16 v[150:151], v163 offset:15360
    s_mov_b64 exec, 1
    ds_add_u32 v152, v153 offset:32
    s_mov_b64 exec, -1
    buffer_load_dwordx4 v[24:27], v2, s[44:47], s66 offen offset:0 sc1
    buffer_load_dwordx4 v[28:31], v2, s[44:47], s66 offen offset:1024 sc1
    buffer_load_dwordx4 v[32:35], v2, s[44:47], s66 offen offset:2048 sc1
    buffer_load_dwordx4 v[36:39], v2, s[44:47], s66 offen offset:3072 sc1
    buffer_load_dwordx4 v[40:43], v2, s[44:47], s62 offen offset:0 sc1
    buffer_load_dwordx4 v[44:47], v2, s[44:47], s62 offen offset:1024 sc1
    buffer_load_dwordx4 v[48:51], v2, s[44:47], s62 offen offset:2048 sc1
    buffer_load_dwordx4 v[52:55], v2, s[44:47], s62 offen offset:3072 sc1
    s_mov_b32 s14, 0x20000
    s_waitcnt lgkmcnt(0)
C_try:
    s_waitcnt vmcnt(7)
    v_mfma_f32_32x32x16_bf16 v[56:71], v[88:91], v[24:27], 0
    v_max3_u32 v160, v24, v25, 0
    v_mfma_f32_32x32x16_bf16 v[72:87], v[92:95], v[24:27], 0
    v_max3_u32 v160, v26, v27, v160
    s_waitcnt vmcnt(6)
    v_mfma_f32_32x32x16_bf16 v[56:71], v[96:99], v[28:31], v[56:71]
    v_max3_u32 v160, v28, v29, v160
    v_mfma_f32_32x32x16_bf16 v[72:87], v[100:103], v[28:31], v[72:87]
    v_max3_u32 v160, v30, v31, v160
    s_waitcnt vmcnt(5)
    v_mfma_f32_32x32x16_bf16 v[56:71], v[104:107], v[32:35], v[56:71]
    v_max3_u32 v160, v32, v33, v160
    v_mfma_f32_32x32x16_bf16 v[72:87], v[108:111], v[32:35], v[72:87]
    v_max3_u32 v160, v34, v35, v160
    s_waitcnt vmcnt(4)
    v_mfma_f32_32x32x16_bf16 v[56:71], v[112:115], v[36:39], v[56:71]
    v_max3_u32 v160, v36, v37, v160
    v_mfma_f32_32x32x16_bf16 v[72:87], v[116:119], v[36:39], v[72:87]
    v_max3_u32 v160, v38, v39, v160
    s_waitcnt vmcnt(3)
    v_mfma_f32_32x32x16_bf16 v[56:71], v[120:123], v[40:43], v[56:71]
    v_max3_u32 v160, v40, v41, v160
    v_mfma_f32_32x32x16_bf16 v[72:87], v[124:127], v[40:43], v[72:87]
    v_max3_u32 v160, v42, v43, v160
    s_waitcnt vmcnt(2)
    v_mfma_f32_32x32x16_bf16 v[56:71], v[128:131], v[44:47], v[56:71]
    v_max3_u32 v160, v44, v45, v160
    v_mfma_f32_32x32x16_bf16 v[72:87], v[132:135], v[44:47], v[72:87]
    v_max3_u32 v160, v46, v47, v160
    s_waitcnt vmcnt(1)
    v_mfma_f32_32x32x16_bf16 v[56:71], v[136:139], v[48:51], v[56:71]
    v_max3_u32 v160, v48, v49, v160
    v_mfma_f32_32x32x16_bf16 v[72:87], v[140:143], v[48:51], v[72:87]
    v_max3_u32 v160, v50, v51, v160
    s_waitcnt vmcnt(0)
    v_mfma_f32_32x32x16_bf16 v[56:71], v[144:147], v[52:55], v[56:71]
    v_max3_u32 v160, v52, v53, v160
    v_mfma_f32_32x32x16_bf16 v[72:87], v[148:151], v[52:55], v[72:87]
    v_max3_u32 v160, v54, v55, v160
    v_cmp_eq_u32 vcc, -1, v160
    s_cbranch_vccz C_ok
    s_sub_u32 s14, s14, 1
    s_cbranch_scc1 C_ok
    s_add_u32 s66, s66, s65
    s_add_u32 s62, s62, s65
    s_sub_u32 s65, 0, s65
    buffer_load_dwordx4 v[24:27], v2, s[44:47], s66 offen offset:0 sc1
    buffer_load_dwordx4 v[28:31], v2, s[44:47], s66 offen offset:1024 sc1
    buffer_load_dwordx4 v[32:35], v2, s[44:47], s66 offen offset:2048 sc1
    buffer_load_dwordx4 v[36:39], v2, s[44:47], s66 offen offset:3072 sc1
    buffer_load_dwordx4 v[40:43], v2, s[44:47], s62 offen offset:0 sc1
    buffer_load_dwordx4 v[44:47], v2, s[44:47], s62 offen offset:1024 sc1
    buffer_load_dwordx4 v[48:51], v2, s[44:47], s62 offen offset:2048 sc1
    buffer_load_dwordx4 v[52:55], v2, s[44:47], s62 offen offset:3072 sc1
    s_branch C_try
C_ok:
W_l9:
    ds_read_b32 v161, v152 offset:32
    s_waitcnt lgkmcnt(0)
    v_readfirstlane_b32 s14, v161
    s_cmp_ge_u32 s14, 12
    s_cbranch_scc0 W_l9
    ds_read_b128 v[24:27], v6 offset:0
    ds_read_b128 v[28:31], v7 offset:0
    ds_read_b128 v[32:35], v6 offset:16384
    ds_read_b128 v[36:39], v7 offset:16384
    ds_read_b128 v[40:43], v6 offset:32768
    ds_read_b128 v[44:47], v7 offset:32768
    ds_read_b128 v[48:51], v6 offset:49152
    ds_read_b128 v[52:55], v7 offset:49152
    ds_write_b128 v20, v[56:59] offset:0
    ds_write_b128 v21, v[60:63] offset:0
    ds_write_b128 v22, v[64:67] offset:0
    ds_write_b128 v23, v[68:71] offset:0
    ds_write_b128 v20, v[72:75] offset:128
    ds_write_b128 v21, v[76:79] offset:128
    ds_write_b128 v22, v[80:83] offset:128
    ds_write_b128 v23, v[84:87] offset:128
    s_waitcnt lgkmcnt(8)
    v_pk_add_f32 v[8:9], v[8:9], v[24:25]
    v_pk_add_f32 v[10:11], v[10:11], v[26:27]
    v_pk_add_f32 v[12:13], v[12:13], v[28:29]
    v_pk_add_f32 v[14:15], v[14:15], v[30:31]
    v_pk_add_f32 v[8:9], v[8:9], v[32:33]
    v_pk_add_f32 v[10:11], v[10:11], v[34:35]
    v_pk_add_f32 v[12:13], v[12:13], v[36:37]
    v_pk_add_f32 v[14:15], v[14:15], v[38:39]
    v_pk_add_f32 v[8:9], v[8:9], v[40:41]
    v_pk_add_f32 v[10:11], v[10:11], v[42:43]
    v_pk_add_f32 v[12:13], v[12:13], v[44:45]
    v_pk_add_f32 v[14:15], v[14:15], v[46:47]
    v_pk_add_f32 v[8:9], v[8:9], v[48:49]
    v_pk_add_f32 v[10:11], v[10:11], v[50:51]
    v_pk_add_f32 v[12:13], v[12:13], v[52:53]
    v_pk_add_f32 v[14:15], v[14:15], v[54:55]
    s_waitcnt lgkmcnt(0)
    s_barrier
    ds_read_b128 v[24:27], v4 offset:0
    ds_read_b128 v[28:31], v5 offset:0
    ds_read_b128 v[32:35], v4 offset:16384
    ds_read_b128 v[36:39], v5 offset:16384
    ds_read_b128 v[40:43], v4 offset:32768
    ds_read_b128 v[44:47], v5 offset:32768
    ds_read_b128 v[48:51], v4 offset:49152
    ds_read_b128 v[52:55], v5 offset:49152
    s_waitcnt lgkmcnt(6)
    v_pk_add_f32 v[8:9], v[8:9], v[24:25]
    v_pk_add_f32 v[10:11], v[10:11], v[26:27]
    v_pk_add_f32 v[12:13], v[12:13], v[28:29]
    v_pk_add_f32 v[14:15], v[14:15], v[30:31]
    s_waitcnt lgkmcnt(4)
    v_pk_add_f32 v[8:9], v[8:9], v[32:33]
    v_pk_add_f32 v[10:11], v[10:11], v[34:35]
    v_pk_add_f32 v[12:13], v[12:13], v[36:37]
    v_pk_add_f32 v[14:15], v[14:15], v[38:39]
    s_waitcnt lgkmcnt(2)
    v_pk_add_f32 v[8:9], v[8:9], v[40:41]
    v_pk_add_f32 v[10:11], v[10:11], v[42:43]
    v_pk_add_f32 v[12:13], v[12:13], v[44:45]
    v_pk_add_f32 v[14:15], v[14:15], v[46:47]
    s_waitcnt lgkmcnt(0)
    v_pk_add_f32 v[8:9], v[8:9], v[48:49]
    v_pk_add_f32 v[10:11], v[10:11], v[50:51]
    v_pk_add_f32 v[12:13], v[12:13], v[52:53]
    v_pk_add_f32 v[14:15], v[14:15], v[54:55]
    v_cvt_pk_bf16_f32 v20, v8, v9
    v_cvt_pk_bf16_f32 v21, v10, v11
    v_cvt_pk_bf16_f32 v22, v12, v13
    v_cvt_pk_bf16_f32 v23, v14, v15
    buffer_store_dwordx4 v[20:23], v167, s[48:51], s58 offen sc1
L_fin:
L_end:
    s_endpgm
K_not:
    s_bitcmp0_b32 s1, 0
    s_cbranch_scc1 K_n2
    buffer_load_dword v28, v113, s[44:47], s63 offen sc1
    s_waitcnt vmcnt(0)
    v_cmp_ne_u32 vcc, s55, v28
    s_cbranch_vccz K_slow
K_n2:
    buffer_load_dwordx4 v[32:35], v2, s[44:47], s59 offen offset:0 sc1
    buffer_load_dwordx4 v[36:39], v2, s[44:47], s59 offen offset:1024 sc1
    buffer_load_dwordx4 v[40:43], v2, s[44:47], s59 offen offset:2048 sc1
    buffer_load_dwordx4 v[44:47], v2, s[44:47], s59 offen offset:3072 sc1
    buffer_load_dwordx4 v[48:51], v2, s[44:47], s64 offen offset:0 sc1
    buffer_load_dwordx4 v[52:55], v2, s[44:47], s64 offen offset:1024 sc1
    buffer_load_dwordx4 v[56:59], v2, s[44:47], s64 offen offset:2048 sc1
    buffer_load_dwordx4 v[60:63], v2, s[44:47], s64 offen offset:3072 sc1
    s_sub_u32 s1, s1, 1
    s_cbranch_scc0 K_chk
K_slow:
    s_mov_b32 m0, s15
    s_nop 0
    buffer_load_dwordx4 v2, s[44:47], s62 offen sc1 lds
    buffer_load_dwordx4 v2, s[44:47], s62 offen offset:1024 sc1 lds
    buffer_load_dwordx4 v2, s[44:47], s62 offen offset:2048 sc1 lds
    buffer_load_dwordx4 v2, s[44:47], s62 offen offset:3072 sc1 lds
    s_waitcnt vmcnt(0)
    s_branch K_done
A_old:
    s_cmp_eq_u32 s54, 0
    s_cbranch_scc1 A_w3
    v_and_b32 v64, 2, v22
    v_xor_b32 v64, v64, v20
    v_lshlrev_b32 v64, 4, v64
    v_lshl_add_u32 v64, v22, 10, v64
    v_xor_b32 v65, 64, v64
    v_add_u32 v66, 14336, v64
    v_add_u32 v67, 21504, v65
    v_add_u32 v65, 7168, v65
    s_lshl_b32 s64, s53, 7
    s_and_b32 s3, s54, 1
    s_lshl_b32 s65, s3, 15
    s_lshl_b32 s3, s3, 18
    s_add_u32 s64, s64, s3
    s_mov_b32 s59, 8
W_l10:
    ds_read_b32 v161, v152 offset:0
    s_waitcnt lgkmcnt(0)
    v_readfirstlane_b32 s14, v161
    s_cmp_ge_u32 s14, 8
    s_cbranch_scc1 W_o10
    s_sleep 1
    s_branch W_l10
W_o10:
A_sl:
    s_mov_b32 m0, s65
    s_add_u32 s65, s65, 4096
    buffer_load_dwordx4 v64, s[32:35], s64 offen lds
    buffer_load_dwordx4 v65, s[32:35], s64 offen offset:1024 lds
    buffer_load_dwordx4 v66, s[32:35], s64 offen offset:2048 lds
    buffer_load_dwordx4 v67, s[32:35], s64 offen offset:3072 lds
    s_add_u32 s64, s64, 32768
    s_waitcnt vmcnt(16)
    s_sub_u32 s59, s59, 1
    s_cmp_lg_u32 s59, 0
    s_cbranch_scc1 A_sl
    s_waitcnt vmcnt(0)
    s_mov_b64 exec, 1
    ds_add_u32 v152, v153 offset:80
    s_mov_b64 exec, -1
    s_branch A_qw
A_w3:
    s_branch A_qw
G_mm:
    s_mov_b64 exec, -1
    s_setprio 0
    s_mov_b32 s32, s16
    s_and_b32 s33, s17, 0xffff
    s_mov_b32 s34, 1409024
    s_mov_b32 s36, s12
    s_and_b32 s37, s13, 0xffff
    s_mov_b32 s38, 524288
    s_sub_u32 s67, s53, 5
    s_max_i32 s67, s67, 0
    s_mul_i32 s3, s53, 5
    s_add_u32 s67, s67, s3
    v_bfe_u32 v11, v1, 2, 1
    v_bfe_u32 v14, v22, 1, 1
    v_xor_b32 v11, v11, v14
    v_lshlrev_b32 v14, 4, v17
    v_lshl_add_u32 v14, v11, 6, v14
    v_lshl_add_u32 v162, v22, 10, v14
    s_lshl_b32 s3, s53, 7
    v_add_u32 v162, s3, v162
    s_cmp_eq_u32 s60, 3
    s_cbranch_scc1 H_start
    s_mov_b32 s40, s18
    s_and_b32 s41, s19, 0xffff
    s_mov_b32 s42, 2752
    s_mov_b32 s43, 0x00020000
    s_lshl_b32 s3, s60, 1
    s_add_u32 s63, s67, s3
    s_cmp_lt_u32 s53, 5
    s_cselect_b32 s3, 2, 99
    s_cmp_eq_u32 s60, s3
    s_cselect_b32 s69, 1, 0
    s_lshl_b32 s66, s60, 13
    s_add_u32 s66, s66, 131072
    v_lshl_add_u32 v12, v157, 9, v158
    v_add_u32 v12, s66, v12
    v_xor_b32 v13, 64, v12
    s_lshl_b32 s62, s63, 6
    v_mul_u32_u24 v10, 2752, v22
    v_add3_u32 v14, v10, v14, s62
    v_and_b32 v11, s69, v11
    v_lshl_add_u32 v14, v11, 30, v14
    v_add_u32 v15, 20992, v14
    v_xor_b32 v4, v154, v157
    v_lshlrev_b32 v4, 4, v4
    v_lshl_add_u32 v4, v156, 8, v4
    v_add_u32 v4, 65536, v4
    v_xor_b32 v5, 32, v4
    v_xor_b32 v6, 64, v4
    v_xor_b32 v7, 96, v4
    v_xor_b32 v8, 128, v4
    v_xor_b32 v9, 160, v4
    v_xor_b32 v10, 192, v4
    v_xor_b32 v11, 224, v4
    v_lshlrev_b32 v18, 1, v156
    v_lshl_add_u32 v18, v157, 16, v18
    s_mov_b32 s65, 0
    v_mov_b32 v160, v152
    v_mov_b32 v104, 0x3f80
    v_mov_b32 v97, 0
    v_mov_b32 v98, 0
    v_mov_b32 v99, 0
    v_mov_b32 v101, 0
    v_mov_b32 v102, 0
    v_mov_b32 v103, 0
    v_mov_b32 v105, 0
    v_mov_b32 v106, 0
    v_mov_b32 v107, 0
    buffer_load_ushort v96, v18, s[40:43], s62 offen
    buffer_load_ushort v100, v18, s[40:43], s62 offen offset:64
W_l11:
    ds_read_b32 v161, v152 offset:64
    s_waitcnt lgkmcnt(0)
    v_readfirstlane_b32 s14, v161
    s_cmp_ge_u32 s14, 1
    s_cbranch_scc1 W_o11
    s_sleep 1
    s_branch W_l11
W_o11:
    ds_read_b32 v163, v152 offset:176
    s_waitcnt vmcnt(0)
    v_mfma_f32_32x32x16_bf16 v[16:31], v[96:99], v[104:107], 0
    v_mfma_f32_32x32x16_bf16 v[32:47], v[96:99], v[104:107], 0
    v_mfma_f32_32x32x16_bf16 v[48:63], v[100:103], v[104:107], 0
    v_mfma_f32_32x32x16_bf16 v[64:79], v[100:103], v[104:107], 0
W_l12:
    ds_read_b32 v161, v152 offset:96
    s_waitcnt lgkmcnt(0)
    v_readfirstlane_b32 s14, v161
    s_cmp_ge_u32 s14, 4
    s_cbranch_scc1 W_o12
    s_sleep 1
    s_branch W_l12
W_o12:
    v_readfirstlane_b32 s55, v163
    s_setprio 3
W_l13:
    ds_read_b32 v161, v152 offset:112
    s_waitcnt lgkmcnt(0)
    v_readfirstlane_b32 s14, v161
    s_cmp_ge_u32 s14, 4
    s_cbranch_scc1 W_o13
    s_sleep 2
    s_branch W_l13
W_o13:
W_l14:
    ds_read_b32 v161, v152 offset:256
    s_waitcnt lgkmcnt(0)
    v_readfirstlane_b32 s14, v161
    s_cmp_ge_u32 s14, 8
    s_cbranch_scc1 W_o14
    s_sleep 1
    s_branch W_l14
W_o14:
    s_add_u32 m0, s66, 0
    s_nop 0
    buffer_load_dwordx4 v14, s[32:35], s65 offen lds
    buffer_load_dwordx4 v15, s[32:35], s65 offen offset:1024 lds
    s_add_u32 s65, s65, 44032
    s_add_u32 m0, s66, 2048
    s_nop 0
    buffer_load_dwordx4 v14, s[32:35], s65 offen lds
    buffer_load_dwordx4 v15, s[32:35], s65 offen offset:1024 lds
    s_add_u32 s65, s65, 44032
    s_add_u32 m0, s66, 4096
    s_nop 0
    buffer_load_dwordx4 v14, s[32:35], s65 offen lds
    buffer_load_dwordx4 v15, s[32:35], s65 offen offset:1024 lds
    s_add_u32 s65, s65, 44032
    s_add_u32 m0, s66, 6144
    s_nop 0
    buffer_load_dwordx4 v14, s[32:35], s65 offen lds
    buffer_load_dwordx4 v15, s[32:35], s65 offen offset:1024 lds
    s_add_u32 s65, s65, 44032
    s_waitcnt vmcnt(6)
    ds_read_b128 v[88:91], v4 offset:0
    ds_read_b128 v[92:95], v4 offset:8192
    ds_read_b64_tr_b16 v[80:81], v12 offset:0
    ds_read_b64_tr_b16 v[82:83], v12 offset:512
    ds_read_b64_tr_b16 v[84:85], v13 offset:0
    ds_read_b64_tr_b16 v[86:87], v13 offset:512
    s_setprio 0
    s_mov_b32 s58, 44032
    s_mov_b32 s64, 4
G_l1:
    s_waitcnt lgkmcnt(0)
    v_mfma_f32_32x32x16_bf16 v[16:31], v[80:83], v[88:91], v[16:31]
    ds_read_b128 v[104:107], v5 offset:0
    ds_read_b128 v[108:111], v5 offset:8192
    s_add_u32 m0, s66, 0
    s_waitcnt vmcnt(4)
    v_mfma_f32_32x32x16_bf16 v[32:47], v[80:83], v[92:95], v[32:47]
    ds_read_b64_tr_b16 v[96:97], v12 offset:2048
    ds_read_b64_tr_b16 v[98:99], v12 offset:2560
    ds_read_b64_tr_b16 v[100:101], v13 offset:2048
    ds_read_b64_tr_b16 v[102:103], v13 offset:2560
    v_mfma_f32_32x32x16_bf16 v[48:63], v[84:87], v[88:91], v[48:63]
    buffer_load_dwordx4 v14, s[32:35], s65 offen lds
    v_mfma_f32_32x32x16_bf16 v[64:79], v[84:87], v[92:95], v[64:79]
    buffer_load_dwordx4 v15, s[32:35], s65 offen offset:1024 lds
    s_add_u32 s65, s65, s58
    s_waitcnt lgkmcnt(0)
    v_mfma_f32_32x32x16_bf16 v[16:31], v[96:99], v[104:107], v[16:31]
    ds_read_b128 v[88:91], v6 offset:0
    ds_read_b128 v[92:95], v6 offset:8192
    s_add_u32 m0, s66, 2048
    s_waitcnt vmcnt(4)
    v_mfma_f32_32x32x16_bf16 v[32:47], v[96:99], v[108:111], v[32:47]
    ds_read_b64_tr_b16 v[80:81], v12 offset:4096
    ds_read_b64_tr_b16 v[82:83], v12 offset:4608
    ds_read_b64_tr_b16 v[84:85], v13 offset:4096
    ds_read_b64_tr_b16 v[86:87], v13 offset:4608
    v_mfma_f32_32x32x16_bf16 v[48:63], v[100:103], v[104:107], v[48:63]
    buffer_load_dwordx4 v14, s[32:35], s65 offen lds
    v_mfma_f32_32x32x16_bf16 v[64:79], v[100:103], v[108:111], v[64:79]
    buffer_load_dwordx4 v15, s[32:35], s65 offen offset:1024 lds
    s_add_u32 s65, s65, s58
    s_waitcnt lgkmcnt(0)
    v_mfma_f32_32x32x16_bf16 v[16:31], v[80:83], v[88:91], v[16:31]
    ds_read_b128 v[104:107], v7 offset:0
    ds_read_b128 v[108:111], v7 offset:8192
    s_add_u32 m0, s66, 4096
    s_waitcnt vmcnt(4)
    v_mfma_f32_32x32x16_bf16 v[32:47], v[80:83], v[92:95], v[32:47]
    ds_read_b64_tr_b16 v[96:97], v12 offset:6144
    ds_read_b64_tr_b16 v[98:99], v12 offset:6656
    ds_read_b64_tr_b16 v[100:101], v13 offset:6144
    ds_read_b64_tr_b16 v[102:103], v13 offset:6656
    v_mfma_f32_32x32x16_bf16 v[48:63], v[84:87], v[88:91], v[48:63]
    buffer_load_dwordx4 v14, s[32:35], s65 offen lds
    v_mfma_f32_32x32x16_bf16 v[64:79], v[84:87], v[92:95], v[64:79]
    buffer_load_dwordx4 v15, s[32:35], s65 offen offset:1024 lds
    s_add_u32 s65, s65, s58
    s_waitcnt lgkmcnt(0)
    v_mfma_f32_32x32x16_bf16 v[16:31], v[96:99], v[104:107], v[16:31]
    ds_read_b128 v[88:91], v8 offset:0
    ds_read_b128 v[92:95], v8 offset:8192
    s_add_u32 m0, s66, 6144
    s_waitcnt vmcnt(4)
    v_mfma_f32_32x32x16_bf16 v[32:47], v[96:99], v[108:111], v[32:47]
    ds_read_b64_tr_b16 v[80:81], v12 offset:0
    ds_read_b64_tr_b16 v[82:83], v12 offset:512
    ds_read_b64_tr_b16 v[84:85], v13 offset:0
    ds_read_b64_tr_b16 v[86:87], v13 offset:512
    v_mfma_f32_32x32x16_bf16 v[48:63], v[100:103], v[104:107], v[48:63]
    buffer_load_dwordx4 v14, s[32:35], s65 offen lds
    v_mfma_f32_32x32x16_bf16 v[64:79], v[100:103], v[108:111], v[64:79]
    buffer_load_dwordx4 v15, s[32:35], s65 offen offset:1024 lds
    s_add_u32 s65, s65, s58
    s_cmp_eq_u32 s64, 1
    s_cbranch_scc1 G_sw
G_swr:
    s_waitcnt lgkmcnt(0)
    v_mfma_f32_32x32x16_bf16 v[16:31], v[80:83], v[88:91], v[16:31]
    ds_read_b128 v[104:107], v9 offset:0
    ds_read_b128 v[108:111], v9 offset:8192
    s_add_u32 m0, s66, 0
    s_waitcnt vmcnt(4)
    v_mfma_f32_32x32x16_bf16 v[32:47], v[80:83], v[92:95], v[32:47]
    ds_read_b64_tr_b16 v[96:97], v12 offset:2048
    ds_read_b64_tr_b16 v[98:99], v12 offset:2560
    ds_read_b64_tr_b16 v[100:101], v13 offset:2048
    ds_read_b64_tr_b16 v[102:103], v13 offset:2560
    v_mfma_f32_32x32x16_bf16 v[48:63], v[84:87], v[88:91], v[48:63]
    buffer_load_dwordx4 v14, s[32:35], s65 offen lds
    v_mfma_f32_32x32x16_bf16 v[64:79], v[84:87], v[92:95], v[64:79]
    buffer_load_dwordx4 v15, s[32:35], s65 offen offset:1024 lds
    s_add_u32 s65, s65, s58
    s_waitcnt lgkmcnt(0)
    v_mfma_f32_32x32x16_bf16 v[16:31], v[96:99], v[104:107], v[16:31]
    ds_read_b128 v[88:91], v10 offset:0
    ds_read_b128 v[92:95], v10 offset:8192
    s_add_u32 m0, s66, 2048
    s_waitcnt vmcnt(4)
    v_mfma_f32_32x32x16_bf16 v[32:47], v[96:99], v[108:111], v[32:47]
    ds_read_b64_tr_b16 v[80:81], v12 offset:4096
    ds_read_b64_tr_b16 v[82:83], v12 offset:4608
    ds_read_b64_tr_b16 v[84:85], v13 offset:4096
    ds_read_b64_tr_b16 v[86:87], v13 offset:4608
    v_mfma_f32_32x32x16_bf16 v[48:63], v[100:103], v[104:107], v[48:63]
    buffer_load_dwordx4 v14, s[32:35], s65 offen lds
    v_mfma_f32_32x32x16_bf16 v[64:79], v[100:103], v[108:111], v[64:79]
    buffer_load_dwordx4 v15, s[32:35], s65 offen offset:1024 lds
    s_add_u32 s65, s65, s58
    s_waitcnt lgkmcnt(0)
    v_mfma_f32_32x32x16_bf16 v[16:31], v[80:83], v[88:91], v[16:31]
    ds_read_b128 v[104:107], v11 offset:0
    ds_read_b128 v[108:111], v11 offset:8192
    s_add_u32 m0, s66, 4096
    s_waitcnt vmcnt(4)
    v_mfma_f32_32x32x16_bf16 v[32:47], v[80:83], v[92:95], v[32:47]
    ds_read_b64_tr_b16 v[96:97], v12 offset:6144
    ds_read_b64_tr_b16 v[98:99], v12 offset:6656
    ds_read_b64_tr_b16 v[100:101], v13 offset:6144
    ds_read_b64_tr_b16 v[102:103], v13 offset:6656
    v_mfma_f32_32x32x16_bf16 v[48:63], v[84:87], v[88:91], v[48:63]
    buffer_load_dwordx4 v14, s[32:35], s65 offen lds
    v_mfma_f32_32x32x16_bf16 v[64:79], v[84:87], v[92:95], v[64:79]
    buffer_load_dwordx4 v15, s[32:35], s65 offen offset:1024 lds
    s_add_u32 s65, s65, s58
    s_setprio 3
    s_mov_b64 exec, 1
    ds_add_u32 v160, v153 offset:320
    s_mov_b64 exec, -1
    v_add_u32 v4, 16384, v4
    v_add_u32 v5, 16384, v5
    v_add_u32 v6, 16384, v6
    v_add_u32 v7, 16384, v7
    v_add_u32 v8, 16384, v8
    v_add_u32 v9, 16384, v9
    v_add_u32 v10, 16384, v10
    v_add_u32 v11, 16384, v11
    v_add_u32 v160, 16, v160
    s_setprio 0
    s_waitcnt lgkmcnt(0)
    v_mfma_f32_32x32x16_bf16 v[16:31], v[96:99], v[104:107], v[16:31]
    ds_read_b128 v[88:91], v4 offset:0
    ds_read_b128 v[92:95], v4 offset:8192
    s_add_u32 m0, s66, 6144
    s_waitcnt vmcnt(4)
    v_mfma_f32_32x32x16_bf16 v[32:47], v[96:99], v[108:111], v[32:47]
    ds_read_b64_tr_b16 v[80:81], v12 offset:0
    ds_read_b64_tr_b16 v[82:83], v12 offset:512
    ds_read_b64_tr_b16 v[84:85], v13 offset:0
    ds_read_b64_tr_b16 v[86:87], v13 offset:512
    v_mfma_f32_32x32x16_bf16 v[48:63], v[100:103], v[104:107], v[48:63]
    buffer_load_dwordx4 v14, s[32:35], s65 offen lds
    v_mfma_f32_32x32x16_bf16 v[64:79], v[100:103], v[108:111], v[64:79]
    buffer_load_dwordx4 v15, s[32:35], s65 offen offset:1024 lds
    s_add_u32 s65, s65, s58
    s_sub_u32 s64, s64, 1
    s_cmp_lg_u32 s64, 0
    s_cbranch_scc1 G_l1
    s_setprio 3
    s_mul_i32 s3, s52, 172
    s_lshl_b32 s63, s63, 1
    s_add_u32 s3, s3, s63
    s_lshl_b32 s3, s3, 10
    s_add_u32 s62, s3, 4456448
    s_add_u32 s63, s62, 88064
    s_nop 4
    v_max_f32 v16, 0, v16
    v_max_f32 v17, 0, v17
    v_max_f32 v18, 0, v18
    v_max_f32 v19, 0, v19
    v_max_f32 v20, 0, v20
    v_max_f32 v21, 0, v21
    v_max_f32 v22, 0, v22
    v_max_f32 v23, 0, v23
    v_max_f32 v24, 0, v24
    v_max_f32 v25, 0, v25
    v_max_f32 v26, 0, v26
    v_max_f32 v27, 0, v27
    v_max_f32 v28, 0, v28
    v_max_f32 v29, 0, v29
    v_max_f32 v30, 0, v30
    v_max_f32 v31, 0, v31
    v_pk_mul_f32 v[16:17], v[16:17], v[16:17]
    v_pk_mul_f32 v[18:19], v[18:19], v[18:19]
    v_pk_mul_f32 v[20:21], v[20:21], v[20:21]
    v_pk_mul_f32 v[22:23], v[22:23], v[22:23]
    v_pk_mul_f32 v[24:25], v[24:25], v[24:25]
    v_pk_mul_f32 v[26:27], v[26:27], v[26:27]
    v_pk_mul_f32 v[28:29], v[28:29], v[28:29]
    v_pk_mul_f32 v[30:31], v[30:31], v[30:31]
    v_cvt_pk_bf16_f32 v112, v16, v17
    v_cvt_pk_bf16_f32 v113, v18, v19
    v_cvt_pk_bf16_f32 v114, v20, v21
    v_cvt_pk_bf16_f32 v115, v22, v23
    v_cvt_pk_bf16_f32 v116, v24, v25
    v_cvt_pk_bf16_f32 v117, v26, v27
    v_cvt_pk_bf16_f32 v118, v28, v29
    v_cvt_pk_bf16_f32 v119, v30, v31
    buffer_store_dwordx4 v[112:115], v2, s[44:47], s62 offen offset:0 sc1
    buffer_store_dwordx4 v[116:119], v2, s[44:47], s62 offen offset:1024 sc1
    v_max_f32 v32, 0, v32
    v_max_f32 v33, 0, v33
    v_max_f32 v34, 0, v34
    v_max_f32 v35, 0, v35
    v_max_f32 v36, 0, v36
    v_max_f32 v37, 0, v37
    v_max_f32 v38, 0, v38
    v_max_f32 v39, 0, v39
    v_max_f32 v40, 0, v40
    v_max_f32 v41, 0, v41
    v_max_f32 v42, 0, v42
    v_max_f32 v43, 0, v43
    v_max_f32 v44, 0, v44
    v_max_f32 v45, 0, v45
    v_max_f32 v46, 0, v46
    v_max_f32 v47, 0, v47
    v_pk_mul_f32 v[32:33], v[32:33], v[32:33]
    v_pk_mul_f32 v[34:35], v[34:35], v[34:35]
    v_pk_mul_f32 v[36:37], v[36:37], v[36:37]
    v_pk_mul_f32 v[38:39], v[38:39], v[38:39]
    v_pk_mul_f32 v[40:41], v[40:41], v[40:41]
    v_pk_mul_f32 v[42:43], v[42:43], v[42:43]
    v_pk_mul_f32 v[44:45], v[44:45], v[44:45]
    v_pk_mul_f32 v[46:47], v[46:47], v[46:47]
    v_cvt_pk_bf16_f32 v120, v32, v33
    v_cvt_pk_bf16_f32 v121, v34, v35
    v_cvt_pk_bf16_f32 v122, v36, v37
    v_cvt_pk_bf16_f32 v123, v38, v39
    v_cvt_pk_bf16_f32 v124, v40, v41
    v_cvt_pk_bf16_f32 v125, v42, v43
    v_cvt_pk_bf16_f32 v126, v44, v45
    v_cvt_pk_bf16_f32 v127, v46, v47
    s_waitcnt vmcnt(2)
    buffer_store_dwordx4 v[120:123], v2, s[44:47], s63 offen offset:0 sc1
    buffer_store_dwordx4 v[124:127], v2, s[44:47], s63 offen offset:1024 sc1
    s_cmp_lg_u32 s69, 0
    s_cbranch_scc1 G_hst
    v_max_f32 v48, 0, v48
    v_max_f32 v49, 0, v49
    v_max_f32 v50, 0, v50
    v_max_f32 v51, 0, v51
    v_max_f32 v52, 0, v52
    v_max_f32 v53, 0, v53
    v_max_f32 v54, 0, v54
    v_max_f32 v55, 0, v55
    v_max_f32 v56, 0, v56
    v_max_f32 v57, 0, v57
    v_max_f32 v58, 0, v58
    v_max_f32 v59, 0, v59
    v_max_f32 v60, 0, v60
    v_max_f32 v61, 0, v61
    v_max_f32 v62, 0, v62
    v_max_f32 v63, 0, v63
    v_pk_mul_f32 v[48:49], v[48:49], v[48:49]
    v_pk_mul_f32 v[50:51], v[50:51], v[50:51]
    v_pk_mul_f32 v[52:53], v[52:53], v[52:53]
    v_pk_mul_f32 v[54:55], v[54:55], v[54:55]
    v_pk_mul_f32 v[56:57], v[56:57], v[56:57]
    v_pk_mul_f32 v[58:59], v[58:59], v[58:59]
    v_pk_mul_f32 v[60:61], v[60:61], v[60:61]
    v_pk_mul_f32 v[62:63], v[62:63], v[62:63]
    v_cvt_pk_bf16_f32 v128, v48, v49
    v_cvt_pk_bf16_f32 v129, v50, v51
    v_cvt_pk_bf16_f32 v130, v52, v53
    v_cvt_pk_bf16_f32 v131, v54, v55
    v_cvt_pk_bf16_f32 v132, v56, v57
    v_cvt_pk_bf16_f32 v133, v58, v59
    v_cvt_pk_bf16_f32 v134, v60, v61
    v_cvt_pk_bf16_f32 v135, v62, v63
    buffer_store_dwordx4 v[128:131], v2, s[44:47], s62 offen offset:2048 sc1
    buffer_store_dwordx4 v[132:135], v2, s[44:47], s62 offen offset:3072 sc1
    v_max_f32 v64, 0, v64
    v_max_f32 v65, 0, v65
    v_max_f32 v66, 0, v66
    v_max_f32 v67, 0, v67
    v_max_f32 v68, 0, v68
    v_max_f32 v69, 0, v69
    v_max_f32 v70, 0, v70
    v_max_f32 v71, 0, v71
    v_max_f32 v72, 0, v72
    v_max_f32 v73, 0, v73
    v_max_f32 v74, 0, v74
    v_max_f32 v75, 0, v75
    v_max_f32 v76, 0, v76
    v_max_f32 v77, 0, v77
    v_max_f32 v78, 0, v78
    v_max_f32 v79, 0, v79
    v_pk_mul_f32 v[64:65], v[64:65], v[64:65]
    v_pk_mul_f32 v[66:67], v[66:67], v[66:67]
    v_pk_mul_f32 v[68:69], v[68:69], v[68:69]
    v_pk_mul_f32 v[70:71], v[70:71], v[70:71]
    v_pk_mul_f32 v[72:73], v[72:73], v[72:73]
    v_pk_mul_f32 v[74:75], v[74:75], v[74:75]
    v_pk_mul_f32 v[76:77], v[76:77], v[76:77]
    v_pk_mul_f32 v[78:79], v[78:79], v[78:79]
    v_cvt_pk_bf16_f32 v136, v64, v65
    v_cvt_pk_bf16_f32 v137, v66, v67
    v_cvt_pk_bf16_f32 v138, v68, v69
    v_cvt_pk_bf16_f32 v139, v70, v71
    v_cvt_pk_bf16_f32 v140, v72, v73
    v_cvt_pk_bf16_f32 v141, v74, v75
    v_cvt_pk_bf16_f32 v142, v76, v77
    v_cvt_pk_bf16_f32 v143, v78, v79
    buffer_store_dwordx4 v[136:139], v2, s[44:47], s63 offen offset:2048 sc1
    buffer_store_dwordx4 v[140:143], v2, s[44:47], s63 offen offset:3072 sc1
G_hst:
    s_lshl_b32 s59, s52, 12
    s_add_u32 s59, s59, 10223616
    v_lshlrev_b32 v3, 7, v156
    v_add_u32 v12, s66, v158
    v_xor_b32 v13, 64, v12
    s_mul_i32 s62, s52, 176128
    s_add_u32 s62, s62, 4456448
    s_add_u32 s63, s62, 88064
    s_cmp_lt_u32 s53, 5
    s_cselect_b32 s3, 5, 6
    s_cselect_b32 s14, 4, 2
    s_add_u32 s67, s67, s3
    s_lshl_b32 s67, s67, 1
    s_add_u32 s67, s67, s60
    s_cmp_ge_u32 s67, 86
    s_cselect_b32 s3, 86, 0
    s_sub_u32 s67, s67, s3
    s_mov_b32 s65, 0
    s_xor_b32 s58, s69, 1
    s_mov_b32 s61, 0
    s_cmp_lt_u32 s60, s14
    s_cselect_b32 s69, 22, 21
    s_cmp_eq_u32 s60, 3
    s_cbranch_scc1 G_z
    s_waitcnt lgkmcnt(0)
    ds_read_b64_tr_b16 v[80:81], v12 offset:0
    ds_read_b64_tr_b16 v[82:83], v12 offset:1024
    ds_read_b64_tr_b16 v[84:85], v13 offset:0
    ds_read_b64_tr_b16 v[86:87], v13 offset:1024
    ds_read_b64_tr_b16 v[88:89], v12 offset:2048
    ds_read_b64_tr_b16 v[90:91], v12 offset:3072
    ds_read_b64_tr_b16 v[92:93], v13 offset:2048
    ds_read_b64_tr_b16 v[94:95], v13 offset:3072
    s_lshl_b32 s3, s53, 2
    s_add_u32 s3, s3, s60
    s_lshl_b32 s3, s3, 7
    s_add_u32 s3, s3, s59
    s_setprio 0
    s_waitcnt lgkmcnt(4)
    s_mov_b64 exec, 1
    s_waitcnt vmcnt(0)
    buffer_store_dword v163, v159, s[44:47], s3 offen sc1
    s_mov_b64 exec, -1
    v_mfma_f32_32x32x16_bf16 v[16:31], v[80:83], v[112:115], 0
    v_mfma_f32_32x32x16_bf16 v[32:47], v[84:87], v[112:115], 0
    v_mfma_f32_32x32x16_bf16 v[48:63], v[80:83], v[120:123], 0
    v_mfma_f32_32x32x16_bf16 v[64:79], v[84:87], v[120:123], 0
    ds_read_b64_tr_b16 v[96:97], v12 offset:4096
    ds_read_b64_tr_b16 v[98:99], v12 offset:5120
    ds_read_b64_tr_b16 v[100:101], v13 offset:4096
    ds_read_b64_tr_b16 v[102:103], v13 offset:5120
    s_waitcnt lgkmcnt(4)
    v_mfma_f32_32x32x16_bf16 v[16:31], v[88:91], v[116:119], v[16:31]
    v_mfma_f32_32x32x16_bf16 v[32:47], v[92:95], v[116:119], v[32:47]
    v_mfma_f32_32x32x16_bf16 v[48:63], v[88:91], v[124:127], v[48:63]
    v_mfma_f32_32x32x16_bf16 v[64:79], v[92:95], v[124:127], v[64:79]
    s_waitcnt lgkmcnt(0)
    s_cmp_eq_u32 s58, 0
    s_cbranch_scc1 G_pro
    ds_read_b64_tr_b16 v[80:81], v12 offset:6144
    ds_read_b64_tr_b16 v[82:83], v12 offset:7168
    ds_read_b64_tr_b16 v[84:85], v13 offset:6144
    ds_read_b64_tr_b16 v[86:87], v13 offset:7168
    v_mfma_f32_32x32x16_bf16 v[16:31], v[96:99], v[128:131], v[16:31]
    v_mfma_f32_32x32x16_bf16 v[32:47], v[100:103], v[128:131], v[32:47]
    v_mfma_f32_32x32x16_bf16 v[48:63], v[96:99], v[136:139], v[48:63]
    v_mfma_f32_32x32x16_bf16 v[64:79], v[100:103], v[136:139], v[64:79]
    s_waitcnt lgkmcnt(0)
    v_mfma_f32_32x32x16_bf16 v[16:31], v[80:83], v[132:135], v[16:31]
    v_mfma_f32_32x32x16_bf16 v[32:47], v[84:87], v[132:135], v[32:47]
    v_mfma_f32_32x32x16_bf16 v[48:63], v[80:83], v[140:143], v[48:63]
    v_mfma_f32_32x32x16_bf16 v[64:79], v[84:87], v[140:143], v[64:79]
G_pro:
    s_setprio 3
W_l15:
    ds_read_b32 v161, v152 offset:544
    s_waitcnt lgkmcnt(0)
    v_readfirstlane_b32 s14, v161
    s_cmp_ge_u32 s14, 8
    s_cbranch_scc1 W_o15
    s_sleep 2
    s_branch W_l15
W_o15:
G_pro1:
    s_mov_b32 s58, 0
    s_lshl_b32 s15, s60, 14
    s_lshl_b32 s68, s60, 17
    s_mov_b32 s64, 8
G_woa:
    s_mov_b32 m0, s15
    s_add_u32 s15, s15, 2048
    buffer_load_dwordx4 v162, s[36:39], s68 offen lds
    buffer_load_dwordx4 v15, s[36:39], s68 offen offset:1024 lds
    s_add_u32 s68, s68, 16384
    s_waitcnt vmcnt(8)
    s_cmp_lg_u32 s64, 5
    s_cbranch_scc1 G_wma
    buffer_load_dword v0, v3, s[44:47], s59 offen sc1
G_wma:
    s_sub_u32 s64, s64, 1
    s_cmp_lg_u32 s64, 0
    s_cbranch_scc1 G_woa
    v_cmp_eq_u32 vcc, s55, v0
    s_mov_b32 s65, vcc_lo
G_pro2:
    s_setprio 0
    s_cmp_eq_u32 s65, -1
    s_cbranch_scc1 H_o16
    s_mul_i32 s3, s67, 205
    s_lshr_b32 s3, s3, 11
    s_add_u32 s14, s67, 10
    s_mul_i32 s14, s14, 171
    s_lshr_b32 s14, s14, 11
    s_min_u32 s3, s3, s14
    s_lshl_b32 s3, s3, 2
    s_lshl_b32 s3, 15, s3
    s_and_b32 s14, s3, s65
    s_cmp_eq_u32 s14, s3
    s_cbranch_scc1 H_o16
    s_setprio 3
    s_mov_b32 s1, 0x20000
H_l16:
    buffer_load_dword v0, v3, s[44:47], s59 offen sc1
    s_waitcnt vmcnt(0)
    v_cmp_eq_u32 vcc, s55, v0
    s_mov_b32 s65, vcc_lo
    s_and_b32 s14, s3, s65
    s_cmp_eq_u32 s14, s3
    s_cbranch_scc1 H_p16
    s_sleep 4
    s_sub_u32 s1, s1, 1
    s_cbranch_scc0 H_l16
H_p16:
    s_setprio 0
H_o16:
    s_lshl_b32 s3, s67, 14
    s_add_u32 m0, s66, 0
    s_lshl_b32 s64, s67, 10
    buffer_load_dwordx4 v162, s[32:35], s3 offen lds
    buffer_load_dwordx4 v15, s[32:35], s3 offen offset:1024 lds
    s_add_u32 s3, s64, s62
    s_add_u32 s64, s64, s63
    buffer_load_dwordx4 v[104:107], v2, s[44:47], s3 offen sc1
    s_sub_u32 s69, s69, 1
    s_cmp_le_u32 s69, s61
    s_cselect_b32 s3, 1, 4
    s_add_u32 s67, s67, s3
    s_cmp_ge_u32 s67, 86
    s_cselect_b32 s3, 86, 0
    s_sub_u32 s67, s67, s3
    s_cmp_eq_u32 s69, 3
    s_cselect_b32 s34, 0, s34
    buffer_load_dwordx4 v[108:111], v2, s[44:47], s64 offen sc1
    s_cselect_b32 s62, 0x40000000, s62
    s_cselect_b32 s63, 0x40000000, s63
    s_cselect_b32 s65, -1, s65
    s_cmp_eq_u32 s65, -1
    s_cbranch_scc1 H_o17
    s_mul_i32 s3, s67, 205
    s_lshr_b32 s3, s3, 11
    s_add_u32 s14, s67, 10
    s_mul_i32 s14, s14, 171
    s_lshr_b32 s14, s14, 11
    s_min_u32 s3, s3, s14
    s_lshl_b32 s3, s3, 2
    s_lshl_b32 s3, 15, s3
    s_and_b32 s14, s3, s65
    s_cmp_eq_u32 s14, s3
    s_cbranch_scc1 H_o17
    s_setprio 3
    s_mov_b32 s1, 0x20000
H_l17:
    buffer_load_dword v0, v3, s[44:47], s59 offen sc1
    s_waitcnt vmcnt(0)
    v_cmp_eq_u32 vcc, s55, v0
    s_mov_b32 s65, vcc_lo
    s_and_b32 s14, s3, s65
    s_cmp_eq_u32 s14, s3
    s_cbranch_scc1 H_p17
    s_sleep 4
    s_sub_u32 s1, s1, 1
    s_cbranch_scc0 H_l17
H_p17:
    s_setprio 0
H_o17:
    s_lshl_b32 s3, s67, 14
    s_add_u32 m0, s66, 2048
    s_lshl_b32 s64, s67, 10
    buffer_load_dwordx4 v162, s[32:35], s3 offen lds
    buffer_load_dwordx4 v15, s[32:35], s3 offen offset:1024 lds
    s_add_u32 s3, s64, s62
    s_add_u32 s64, s64, s63
    buffer_load_dwordx4 v[144:147], v2, s[44:47], s3 offen sc1
    s_sub_u32 s69, s69, 1
    s_cmp_le_u32 s69, s61
    s_cselect_b32 s3, 1, 4
    s_add_u32 s67, s67, s3
    s_cmp_ge_u32 s67, 86
    s_cselect_b32 s3, 86, 0
    s_sub_u32 s67, s67, s3
    s_cmp_eq_u32 s69, 3
    s_cselect_b32 s34, 0, s34
    buffer_load_dwordx4 v[148:151], v2, s[44:47], s64 offen sc1
    s_cselect_b32 s62, 0x40000000, s62
    s_cselect_b32 s63, 0x40000000, s63
    s_cselect_b32 s65, -1, s65
    s_cmp_eq_u32 s65, -1
    s_cbranch_scc1 H_o18
    s_mul_i32 s3, s67, 205
    s_lshr_b32 s3, s3, 11
    s_add_u32 s14, s67, 10
    s_mul_i32 s14, s14, 171
    s_lshr_b32 s14, s14, 11
    s_min_u32 s3, s3, s14
    s_lshl_b32 s3, s3, 2
    s_lshl_b32 s3, 15, s3
    s_and_b32 s14, s3, s65
    s_cmp_eq_u32 s14, s3
    s_cbranch_scc1 H_o18
    s_setprio 3
    s_mov_b32 s1, 0x20000
H_l18:
    buffer_load_dword v0, v3, s[44:47], s59 offen sc1
    s_waitcnt vmcnt(0)
    v_cmp_eq_u32 vcc, s55, v0
    s_mov_b32 s65, vcc_lo
    s_and_b32 s14, s3, s65
    s_cmp_eq_u32 s14, s3
    s_cbranch_scc1 H_p18
    s_sleep 4
    s_sub_u32 s1, s1, 1
    s_cbranch_scc0 H_l18
H_p18:
    s_setprio 0
H_o18:
    s_lshl_b32 s3, s67, 14
    s_add_u32 m0, s66, 4096
    s_lshl_b32 s64, s67, 10
    buffer_load_dwordx4 v162, s[32:35], s3 offen lds
    buffer_load_dwordx4 v15, s[32:35], s3 offen offset:1024 lds
    s_add_u32 s3, s64, s62
    s_add_u32 s64, s64, s63
    buffer_load_dwordx4 v[4:7], v2, s[44:47], s3 offen sc1
    s_sub_u32 s69, s69, 1
    s_cmp_le_u32 s69, s61
    s_cselect_b32 s3, 1, 4
    s_add_u32 s67, s67, s3
    s_cmp_ge_u32 s67, 86
    s_cselect_b32 s3, 86, 0
    s_sub_u32 s67, s67, s3
    s_cmp_eq_u32 s69, 3
    s_cselect_b32 s34, 0, s34
    buffer_load_dwordx4 v[8:11], v2, s[44:47], s64 offen sc1
    s_cselect_b32 s62, 0x40000000, s62
    s_cselect_b32 s63, 0x40000000, s63
    s_cselect_b32 s65, -1, s65
    s_waitcnt vmcnt(8)
    ds_read_b64_tr_b16 v[80:81], v12 offset:0
    ds_read_b64_tr_b16 v[82:83], v12 offset:1024
    ds_read_b64_tr_b16 v[84:85], v13 offset:0
    ds_read_b64_tr_b16 v[86:87], v13 offset:1024
G_l2:
    s_waitcnt lgkmcnt(0)
    v_mfma_f32_32x32x16_bf16 v[16:31], v[80:83], v[104:107], v[16:31]
    s_waitcnt vmcnt(4)
    ds_read_b64_tr_b16 v[88:89], v12 offset:2048
    ds_read_b64_tr_b16 v[90:91], v12 offset:3072
    ds_read_b64_tr_b16 v[92:93], v13 offset:2048
    ds_read_b64_tr_b16 v[94:95], v13 offset:3072
    v_mfma_f32_32x32x16_bf16 v[32:47], v[84:87], v[104:107], v[32:47]
    s_cmp_eq_u32 s65, -1
    s_cbranch_scc1 H_o19
    s_mul_i32 s3, s67, 205
    s_lshr_b32 s3, s3, 11
    s_add_u32 s14, s67, 10
    s_mul_i32 s14, s14, 171
    s_lshr_b32 s14, s14, 11
    s_min_u32 s3, s3, s14
    s_lshl_b32 s3, s3, 2
    s_lshl_b32 s3, 15, s3
    s_and_b32 s14, s3, s65
    s_cmp_eq_u32 s14, s3
    s_cbranch_scc1 H_o19
    s_setprio 3
    s_mov_b32 s1, 0x20000
H_l19:
    buffer_load_dword v0, v3, s[44:47], s59 offen sc1
    s_waitcnt vmcnt(0)
    v_cmp_eq_u32 vcc, s55, v0
    s_mov_b32 s65, vcc_lo
    s_and_b32 s14, s3, s65
    s_cmp_eq_u32 s14, s3
    s_cbranch_scc1 H_p19
    s_sleep 4
    s_sub_u32 s1, s1, 1
    s_cbranch_scc0 H_l19
H_p19:
    s_setprio 0
H_o19:
    s_lshl_b32 s3, s67, 14
    s_add_u32 m0, s66, 0
    s_lshl_b32 s64, s67, 10
    buffer_load_dwordx4 v162, s[32:35], s3 offen lds
    buffer_load_dwordx4 v15, s[32:35], s3 offen offset:1024 lds
    v_mfma_f32_32x32x16_bf16 v[48:63], v[80:83], v[108:111], v[48:63]
    s_add_u32 s3, s64, s62
    s_add_u32 s64, s64, s63
    buffer_load_dwordx4 v[104:107], v2, s[44:47], s3 offen sc1
    s_sub_u32 s69, s69, 1
    s_cmp_le_u32 s69, s61
    s_cselect_b32 s3, 1, 4
    s_add_u32 s67, s67, s3
    s_cmp_ge_u32 s67, 86
    s_cselect_b32 s3, 86, 0
    s_sub_u32 s67, s67, s3
    s_cmp_eq_u32 s69, 3
    s_cselect_b32 s34, 0, s34
    v_mfma_f32_32x32x16_bf16 v[64:79], v[84:87], v[108:111], v[64:79]
    buffer_load_dwordx4 v[108:111], v2, s[44:47], s64 offen sc1
    s_cselect_b32 s62, 0x40000000, s62
    s_cselect_b32 s63, 0x40000000, s63
    s_cselect_b32 s65, -1, s65
    s_cmp_eq_u32 s69, 0
    s_cbranch_scc1 G_d2
    s_waitcnt lgkmcnt(0)
    v_mfma_f32_32x32x16_bf16 v[16:31], v[88:91], v[144:147], v[16:31]
    s_waitcnt vmcnt(4)
    ds_read_b64_tr_b16 v[96:97], v12 offset:4096
    ds_read_b64_tr_b16 v[98:99], v12 offset:5120
    ds_read_b64_tr_b16 v[100:101], v13 offset:4096
    ds_read_b64_tr_b16 v[102:103], v13 offset:5120
    v_mfma_f32_32x32x16_bf16 v[32:47], v[92:95], v[144:147], v[32:47]
    s_cmp_eq_u32 s65, -1
    s_cbranch_scc1 H_o20
    s_mul_i32 s3, s67, 205
    s_lshr_b32 s3, s3, 11
    s_add_u32 s14, s67, 10
    s_mul_i32 s14, s14, 171
    s_lshr_b32 s14, s14, 11
    s_min_u32 s3, s3, s14
    s_lshl_b32 s3, s3, 2
    s_lshl_b32 s3, 15, s3
    s_and_b32 s14, s3, s65
    s_cmp_eq_u32 s14, s3
    s_cbranch_scc1 H_o20
    s_setprio 3
    s_mov_b32 s1, 0x20000
H_l20:
    buffer_load_dword v0, v3, s[44:47], s59 offen sc1
    s_waitcnt vmcnt(0)
    v_cmp_eq_u32 vcc, s55, v0
    s_mov_b32 s65, vcc_lo
    s_and_b32 s14, s3, s65
    s_cmp_eq_u32 s14, s3
    s_cbranch_scc1 H_p20
    s_sleep 4
    s_sub_u32 s1, s1, 1
    s_cbranch_scc0 H_l20
H_p20:
    s_setprio 0
H_o20:
    s_lshl_b32 s3, s67, 14
    s_add_u32 m0, s66, 2048
    s_lshl_b32 s64, s67, 10
    buffer_load_dwordx4 v162, s[32:35], s3 offen lds
    buffer_load_dwordx4 v15, s[32:35], s3 offen offset:1024 lds
    v_mfma_f32_32x32x16_bf16 v[48:63], v[88:91], v[148:151], v[48:63]
    s_add_u32 s3, s64, s62
    s_add_u32 s64, s64, s63
    buffer_load_dwordx4 v[144:147], v2, s[44:47], s3 offen sc1
    s_sub_u32 s69, s69, 1
    s_cmp_le_u32 s69, s61
    s_cselect_b32 s3, 1, 4
    s_add_u32 s67, s67, s3
    s_cmp_ge_u32 s67, 86
    s_cselect_b32 s3, 86, 0
    s_sub_u32 s67, s67, s3
    s_cmp_eq_u32 s69, 3
    s_cselect_b32 s34, 0, s34
    v_mfma_f32_32x32x16_bf16 v[64:79], v[92:95], v[148:151], v[64:79]
    buffer_load_dwordx4 v[148:151], v2, s[44:47], s64 offen sc1
    s_cselect_b32 s62, 0x40000000, s62
    s_cselect_b32 s63, 0x40000000, s63
    s_cselect_b32 s65, -1, s65
    s_cmp_eq_u32 s69, 0
    s_cbranch_scc1 G_d2
    s_waitcnt lgkmcnt(0)
    v_mfma_f32_32x32x16_bf16 v[16:31], v[96:99], v[4:7], v[16:31]
    s_waitcnt vmcnt(4)
    ds_read_b64_tr_b16 v[80:81], v12 offset:0
    ds_read_b64_tr_b16 v[82:83], v12 offset:1024
    ds_read_b64_tr_b16 v[84:85], v13 offset:0
    ds_read_b64_tr_b16 v[86:87], v13 offset:1024
    v_mfma_f32_32x32x16_bf16 v[32:47], v[100:103], v[4:7], v[32:47]
    s_cmp_eq_u32 s65, -1
    s_cbranch_scc1 H_o21
    s_mul_i32 s3, s67, 205
    s_lshr_b32 s3, s3, 11
    s_add_u32 s14, s67, 10
    s_mul_i32 s14, s14, 171
    s_lshr_b32 s14, s14, 11
    s_min_u32 s3, s3, s14
    s_lshl_b32 s3, s3, 2
    s_lshl_b32 s3, 15, s3
    s_and_b32 s14, s3, s65
    s_cmp_eq_u32 s14, s3
    s_cbranch_scc1 H_o21
    s_setprio 3
    s_mov_b32 s1, 0x20000
H_l21:
    buffer_load_dword v0, v3, s[44:47], s59 offen sc1
    s_waitcnt vmcnt(0)
    v_cmp_eq_u32 vcc, s55, v0
    s_mov_b32 s65, vcc_lo
    s_and_b32 s14, s3, s65
    s_cmp_eq_u32 s14, s3
    s_cbranch_scc1 H_p21
    s_sleep 4
    s_sub_u32 s1, s1, 1
    s_cbranch_scc0 H_l21
H_p21:
    s_setprio 0
H_o21:
    s_lshl_b32 s3, s67, 14
    s_add_u32 m0, s66, 4096
    s_lshl_b32 s64, s67, 10
    buffer_load_dwordx4 v162, s[32:35], s3 offen lds
    buffer_load_dwordx4 v15, s[32:35], s3 offen offset:1024 lds
    v_mfma_f32_32x32x16_bf16 v[48:63], v[96:99], v[8:11], v[48:63]
    s_add_u32 s3, s64, s62
    s_add_u32 s64, s64, s63
    buffer_load_dwordx4 v[4:7], v2, s[44:47], s3 offen sc1
    s_sub_u32 s69, s69, 1
    s_cmp_le_u32 s69, s61
    s_cselect_b32 s3, 1, 4
    s_add_u32 s67, s67, s3
    s_cmp_ge_u32 s67, 86
    s_cselect_b32 s3, 86, 0
    s_sub_u32 s67, s67, s3
    s_cmp_eq_u32 s69, 3
    s_cselect_b32 s34, 0, s34
    v_mfma_f32_32x32x16_bf16 v[64:79], v[100:103], v[8:11], v[64:79]
    buffer_load_dwordx4 v[8:11], v2, s[44:47], s64 offen sc1
    s_cselect_b32 s62, 0x40000000, s62
    s_cselect_b32 s63, 0x40000000, s63
    s_cselect_b32 s65, -1, s65
    s_cmp_eq_u32 s69, 0
    s_cbranch_scc1 G_d2
    s_branch G_l2
G_d2:
    s_setprio 3
    s_cmp_eq_u32 s58, 0
    s_cbranch_scc1 G_nwo
W_l22:
    ds_read_b32 v161, v152 offset:528
    s_waitcnt lgkmcnt(0)
    v_readfirstlane_b32 s14, v161
    s_cmp_ge_u32 s14, 8
    s_cbranch_scc1 W_o22
    s_sleep 2
    s_branch W_l22
W_o22:
    s_lshl_b32 s15, s60, 14
    s_lshl_b32 s68, s60, 17
    s_mov_b32 s64, 8
G_wob:
    s_mov_b32 m0, s15
    s_add_u32 s15, s15, 2048
    buffer_load_dwordx4 v162, s[36:39], s68 offen lds
    buffer_load_dwordx4 v15, s[36:39], s68 offen offset:1024 lds
    s_add_u32 s68, s68, 16384
    s_waitcnt vmcnt(8)
G_wmb:
    s_sub_u32 s64, s64, 1
    s_cmp_lg_u32 s64, 0
    s_cbranch_scc1 G_wob
G_nwo:
    s_waitcnt vmcnt(0)
    s_lshl_b32 s3, s60, 14
    s_add_u32 s3, s3, 65536
    v_and_b32 v4, 7, v1
    v_xor_b32 v4, v4, v157
    v_lshlrev_b32 v4, 4, v4
    v_lshl_add_u32 v4, v156, 8, v4
    v_add_u32 v4, s3, v4
    v_xor_b32 v5, 32, v4
    v_xor_b32 v6, 64, v4
    v_xor_b32 v7, 96, v4
    s_waitcnt vmcnt(0)
    s_setprio 0
    s_barrier
    ds_write_b128 v4, v[16:19] offset:0
    ds_write_b128 v5, v[20:23] offset:0
    ds_write_b128 v6, v[24:27] offset:0
    ds_write_b128 v7, v[28:31] offset:0
    ds_write_b128 v4, v[32:35] offset:128
    ds_write_b128 v5, v[36:39] offset:128
    ds_write_b128 v6, v[40:43] offset:128
    ds_write_b128 v7, v[44:47] offset:128
    ds_write_b128 v4, v[48:51] offset:8192
    ds_write_b128 v5, v[52:55] offset:8192
    ds_write_b128 v6, v[56:59] offset:8192
    ds_write_b128 v7, v[60:63] offset:8192
    ds_write_b128 v4, v[64:67] offset:8320
    ds_write_b128 v5, v[68:71] offset:8320
    ds_write_b128 v6, v[72:75] offset:8320
    ds_write_b128 v7, v[76:79] offset:8320
    s_mov_b64 exec, 1
    ds_add_u32 v152, v153 offset:32
    s_mov_b64 exec, -1
    s_add_u32 s3, s2, s60
    s_cmp_lg_u32 s3, 0
    s_cbranch_scc1 L_fin
    s_mov_b32 s3, 10092544
    buffer_store_dword v163, v159, s[44:47], s3 offen sc1
    s_branch L_fin
G_sw:
    s_setprio 3
    s_mov_b32 s32, s20
    s_and_b32 s33, s21, 0xffff
    v_mov_b32 v14, v162
    v_add_u32 v15, 7168, v162
    s_lshl_b32 s65, s63, 15
    s_movk_i32 s58, 16384
    s_setprio 0
    s_branch G_swr
G_z:
    s_mov_b32 s32, s20
    s_and_b32 s33, s21, 0xffff
    s_mov_b32 s58, 0
    v_add_u32 v15, 7168, v162
    v_mov_b32 v80, 0
    v_mov_b32 v81, 0
    v_mov_b32 v82, 0
    v_mov_b32 v83, 0
    ds_read_b32 v161, v152 offset:528
    s_nop 0
    v_mfma_f32_32x32x16_bf16 v[16:31], v[80:83], v[80:83], 0
    v_mfma_f32_32x32x16_bf16 v[32:47], v[80:83], v[80:83], 0
    v_mfma_f32_32x32x16_bf16 v[48:63], v[80:83], v[80:83], 0
    v_mfma_f32_32x32x16_bf16 v[64:79], v[80:83], v[80:83], 0
    s_waitcnt lgkmcnt(0)
    v_readfirstlane_b32 s14, v161
    s_cmp_ge_u32 s14, 8
    s_cbranch_scc1 G_pro1
    s_mov_b32 s58, 1
    s_branch G_pro2
H_start:
    s_mov_b32 s66, 155648
    s_mov_b32 s69, 1
    s_lshr_b32 s68, s52, 2
    s_add_u32 s68, s68, 1
    s_and_b32 s68, s68, 7
    s_lshl_b32 s62, s68, 12
    s_add_u32 s62, s62, 10108928
    s_lshl_b32 s68, s68, 14
    s_movk_i32 s15, 16384
    v_lshlrev_b32 v3, 7, v1
    v_lshlrev_b32 v4, 7, v156
    v_mov_b32 v24, -1
    v_mov_b32 v25, -1
    v_mov_b32 v26, -1
    v_mov_b32 v27, -1
    s_setprio 3
W_l23:
    ds_read_b32 v161, v152 offset:16
    s_waitcnt lgkmcnt(0)
    v_readfirstlane_b32 s14, v161
    s_cmp_ge_u32 s14, 4
    s_cbranch_scc1 W_o23
    s_sleep 2
    s_branch W_l23
W_o23:
    ds_read_b32 v163, v152 offset:176
W_l24:
    ds_read_b32 v161, v152 offset:256
    s_waitcnt lgkmcnt(0)
    v_readfirstlane_b32 s14, v161
    s_cmp_ge_u32 s14, 2
    s_cbranch_scc1 W_o24
    s_sleep 1
    s_branch W_l24
W_o24:
    v_readfirstlane_b32 s55, v163
    s_mov_b32 s14, 0x20000
P_l25:
    buffer_load_dword v20, v4, s[44:47], s62 offen sc1
    s_waitcnt vmcnt(0)
P_c25:
    v_cmp_ne_u32 vcc, s55, v20
    s_cbranch_vccz P_o25
    s_sleep 2
    s_sub_u32 s14, s14, 1
    s_cbranch_scc0 P_l25
P_o25:
    s_mov_b32 s64, 4
K_b26:
    s_mov_b32 m0, s15
    s_add_u32 s15, s15, 4096
    buffer_load_dwordx4 v2, s[44:47], s68 offen offset:0 sc1 lds
    buffer_load_dwordx4 v2, s[44:47], s68 offen offset:1024 sc1 lds
    buffer_load_dwordx4 v2, s[44:47], s68 offen offset:2048 sc1 lds
    buffer_load_dwordx4 v2, s[44:47], s68 offen offset:3072 sc1 lds
    s_add_u32 s68, s68, 4096
    s_and_b32 s68, s68, 0x1ffff
    s_waitcnt vmcnt(12)
    s_sub_u32 s64, s64, 1
    s_cmp_lg_u32 s64, 0
    s_cbranch_scc1 K_b26
    s_mov_b32 s62, 10108928
    buffer_load_dword v20, v3, s[44:47], s62 offen sc1
    s_add_u32 s62, s62, 8192
    buffer_load_dword v21, v3, s[44:47], s62 offen sc1
    s_add_u32 s62, s62, 8192
    buffer_load_dword v22, v3, s[44:47], s62 offen sc1
    s_add_u32 s62, s62, 8192
    buffer_load_dword v23, v3, s[44:47], s62 offen sc1
    s_add_u32 s62, s62, 8192
    v_mov_b32 v30, 2
    s_waitcnt vmcnt(4)
    ds_write_b32 v152, v30 offset:272
    s_mov_b32 s14, 0x20000
    s_branch H_fc
H_fl:
    s_mov_b32 s62, 10108928
    buffer_load_dword v20, v3, s[44:47], s62 offen sc1
    s_add_u32 s62, s62, 8192
    buffer_load_dword v21, v3, s[44:47], s62 offen sc1
    s_add_u32 s62, s62, 8192
    buffer_load_dword v22, v3, s[44:47], s62 offen sc1
    s_add_u32 s62, s62, 8192
    buffer_load_dword v23, v3, s[44:47], s62 offen sc1
    s_add_u32 s62, s62, 8192
H_fc:
    s_waitcnt vmcnt(0)
    v_min3_u32 v28, v20, v21, v22
    v_max3_u32 v29, v20, v21, v22
    v_min_u32 v28, v28, v23
    v_max_u32 v29, v29, v23
    v_cmp_ne_u32 vcc, s55, v28
    v_cmp_ne_u32 s[8:9], s55, v29
    s_or_b64 vcc, vcc, s[8:9]
    s_cbranch_vccz H_fo
    s_sleep 4
    s_sub_u32 s14, s14, 1
    s_cbranch_scc0 H_fl
H_fo:
    s_mov_b32 s64, 4
K_b27:
    s_mov_b32 m0, s15
    s_add_u32 s15, s15, 4096
    buffer_load_dwordx4 v2, s[44:47], s68 offen offset:0 sc1 lds
    buffer_load_dwordx4 v2, s[44:47], s68 offen offset:1024 sc1 lds
    buffer_load_dwordx4 v2, s[44:47], s68 offen offset:2048 sc1 lds
    buffer_load_dwordx4 v2, s[44:47], s68 offen offset:3072 sc1 lds
    s_add_u32 s68, s68, 4096
    s_and_b32 s68, s68, 0x1ffff
    s_waitcnt vmcnt(12)
    s_sub_u32 s64, s64, 1
    s_cmp_lg_u32 s64, 0
    s_cbranch_scc1 K_b27
    v_mov_b32 v30, 3
    s_waitcnt vmcnt(0)
    ds_write_b32 v152, v30 offset:272
    s_mov_b32 s64, 4
K_b28:
    s_mov_b32 m0, s15
    s_add_u32 s15, s15, 4096
    buffer_load_dwordx4 v2, s[44:47], s68 offen offset:0 sc1 lds
    buffer_load_dwordx4 v2, s[44:47], s68 offen offset:1024 sc1 lds
    buffer_load_dwordx4 v2, s[44:47], s68 offen offset:2048 sc1 lds
    buffer_load_dwordx4 v2, s[44:47], s68 offen offset:3072 sc1 lds
    s_add_u32 s68, s68, 4096
    s_and_b32 s68, s68, 0x1ffff
    s_waitcnt vmcnt(12)
    s_sub_u32 s64, s64, 1
    s_cmp_lg_u32 s64, 0
    s_cbranch_scc1 K_b28
    v_mov_b32 v30, 4
    s_waitcnt vmcnt(0)
    ds_write_b32 v152, v30 offset:272
    s_lshl_b32 s3, s52, 4
    s_add_u32 s3, s3, s53
    s_lshl_b32 s3, s3, 12
    s_add_u32 s3, s3, 2359296
    buffer_store_dwordx4 v[24:27], v2, s[44:47], s3 offen offset:0 sc1
    buffer_store_dwordx4 v[24:27], v2, s[44:47], s3 offen offset:1024 sc1
    buffer_store_dwordx4 v[24:27], v2, s[44:47], s3 offen offset:2048 sc1
    buffer_store_dwordx4 v[24:27], v2, s[44:47], s3 offen offset:3072 sc1
    s_add_u32 s3, s3, 32768
    buffer_store_dwordx4 v[24:27], v2, s[44:47], s3 offen offset:0 sc1
    buffer_store_dwordx4 v[24:27], v2, s[44:47], s3 offen offset:1024 sc1
    buffer_store_dwordx4 v[24:27], v2, s[44:47], s3 offen offset:2048 sc1
    buffer_store_dwordx4 v[24:27], v2, s[44:47], s3 offen offset:3072 sc1
    s_add_u32 s3, s3, 32768
    s_mov_b32 s28, s20
    s_and_b32 s29, s21, 0xffff
    s_mov_b32 s30, 1409024
    s_mul_i32 s3, s2, 5504
    v_min_u32 v5, 5376, v3
    buffer_load_dword v0, v5, s[28:31], s3 offen
    s_lshl_b32 s3, s2, 11
    v_min_u32 v5, 1920, v3
    buffer_load_dword v0, v5, s[36:39], s3 offen
W_l29:
    ds_read_b32 v161, v152 offset:512
    s_waitcnt lgkmcnt(0)
    v_readfirstlane_b32 s14, v161
    s_cmp_ge_u32 s14, 8
    s_cbranch_scc1 W_o29
    s_sleep 2
    s_branch W_l29
W_o29:
W_l30:
    ds_read_b32 v161, v152 offset:336
    s_waitcnt lgkmcnt(0)
    v_readfirstlane_b32 s14, v161
    s_cmp_ge_u32 s14, 3
    s_cbranch_scc1 W_o30
    s_sleep 4
    s_branch W_l30
W_o30:
    s_mov_b32 s64, 8
K_b31:
    s_mov_b32 m0, s15
    s_add_u32 s15, s15, 4096
    buffer_load_dwordx4 v2, s[44:47], s68 offen offset:0 sc1 lds
    buffer_load_dwordx4 v2, s[44:47], s68 offen offset:1024 sc1 lds
    buffer_load_dwordx4 v2, s[44:47], s68 offen offset:2048 sc1 lds
    buffer_load_dwordx4 v2, s[44:47], s68 offen offset:3072 sc1 lds
    s_add_u32 s68, s68, 4096
    s_and_b32 s68, s68, 0x1ffff
    s_waitcnt vmcnt(12)
    s_sub_u32 s64, s64, 1
    s_cmp_lg_u32 s64, 0
    s_cbranch_scc1 K_b31
    v_mov_b32 v30, 6
    s_waitcnt vmcnt(0)
    ds_write_b32 v152, v30 offset:272
    s_lshl_b32 s3, s52, 3
    s_add_u32 s3, s3, s53
    s_lshl_b32 s3, s3, 9
    s_add_u32 s3, s3, 10224000
    s_mov_b64 exec, 1
    buffer_store_dword v163, v159, s[44:47], s3 offen sc1
    s_mov_b64 exec, -1
W_l32:
    ds_read_b32 v161, v152 offset:368
    s_waitcnt lgkmcnt(0)
    v_readfirstlane_b32 s14, v161
    s_cmp_ge_u32 s14, 3
    s_cbranch_scc1 W_o32
    s_sleep 4
    s_branch W_l32
W_o32:
    s_mov_b32 s64, 8
K_b33:
    s_mov_b32 m0, s15
    s_add_u32 s15, s15, 4096
    buffer_load_dwordx4 v2, s[44:47], s68 offen offset:0 sc1 lds
    buffer_load_dwordx4 v2, s[44:47], s68 offen offset:1024 sc1 lds
    buffer_load_dwordx4 v2, s[44:47], s68 offen offset:2048 sc1 lds
    buffer_load_dwordx4 v2, s[44:47], s68 offen offset:3072 sc1 lds
    s_add_u32 s68, s68, 4096
    s_and_b32 s68, s68, 0x1ffff
    s_waitcnt vmcnt(12)
    s_sub_u32 s64, s64, 1
    s_cmp_lg_u32 s64, 0
    s_cbranch_scc1 K_b33
    v_mov_b32 v30, 16
    s_waitcnt vmcnt(0)
    ds_write_b32 v152, v30 offset:272
    s_branch G_hst
F_start:
    s_mov_b32 s65, 0
    v_mov_b32 v160, 0xff800000
F_mx:
    buffer_load_dwordx4 v[8:11], v2, s[44:47], s65 offen sc1
    s_add_u32 s65, s65, 2048
    s_waitcnt vmcnt(0)
    v_mfma_f32_32x32x16_bf16 v[24:39], v[8:11], v[4:7], 0
    s_nop 11
    v_max3_f32 v160, v160, v24, v25
    v_max3_f32 v160, v160, v26, v27
    v_max3_f32 v160, v160, v28, v29
    v_max3_f32 v160, v160, v30, v31
    v_max3_f32 v160, v160, v32, v33
    v_max3_f32 v160, v160, v34, v35
    v_max3_f32 v160, v160, v36, v37
    v_max3_f32 v160, v160, v38, v39
    s_cmp_lt_u32 s65, 0x20000
    s_cbranch_scc1 F_mx
    v_mov_b32 v161, v160
    s_nop 1
    v_permlane32_swap_b32 v160, v161
    v_max_f32 v160, v160, v161
    s_mov_b32 s65, 0
    v_sub_f32 v56, 0, v160
    v_mov_b32 v72, 0
    v_sub_f32 v57, 0, v160
    v_mov_b32 v73, 0
    v_sub_f32 v58, 0, v160
    v_mov_b32 v74, 0
    v_sub_f32 v59, 0, v160
    v_mov_b32 v75, 0
    v_sub_f32 v60, 0, v160
    v_mov_b32 v76, 0
    v_sub_f32 v61, 0, v160
    v_mov_b32 v77, 0
    v_sub_f32 v62, 0, v160
    v_mov_b32 v78, 0
    v_sub_f32 v63, 0, v160
    v_mov_b32 v79, 0
    v_sub_f32 v64, 0, v160
    v_mov_b32 v80, 0
    v_sub_f32 v65, 0, v160
    v_mov_b32 v81, 0
    v_sub_f32 v66, 0, v160
    v_mov_b32 v82, 0
    v_sub_f32 v67, 0, v160
    v_mov_b32 v83, 0
    v_sub_f32 v68, 0, v160
    v_mov_b32 v84, 0
    v_sub_f32 v69, 0, v160
    v_mov_b32 v85, 0
    v_sub_f32 v70, 0, v160
    v_mov_b32 v86, 0
    v_sub_f32 v71, 0, v160
    v_mov_b32 v87, 0
F_pv:
    buffer_load_dwordx4 v[8:11], v2, s[44:47], s65 offen sc1
    s_mov_b64 exec, s[66:67]
    buffer_load_dwordx4 v[88:91], v3, s[44:47], s65 offen sc1
    buffer_load_dwordx4 v[92:95], v3, s[44:47], s65 offen offset:512 sc1
    s_mov_b64 exec, -1
    s_add_u32 s65, s65, 2048
    s_waitcnt vmcnt(0)
    v_mfma_f32_32x32x16_bf16 v[24:39], v[8:11], v[4:7], v[56:71]
    s_nop 11
    v_exp_f32 v24, v24
    v_exp_f32 v25, v25
    v_exp_f32 v26, v26
    v_exp_f32 v27, v27
    v_exp_f32 v28, v28
    v_exp_f32 v29, v29
    v_exp_f32 v30, v30
    v_exp_f32 v31, v31
    v_exp_f32 v32, v32
    v_exp_f32 v33, v33
    v_exp_f32 v34, v34
    v_exp_f32 v35, v35
    v_exp_f32 v36, v36
    v_exp_f32 v37, v37
    v_exp_f32 v38, v38
    v_exp_f32 v39, v39
    s_nop 1
    v_smfmac_f32_32x32x32_bf16 v[72:87], v[88:91], v[24:31], v20
    v_smfmac_f32_32x32x32_bf16 v[72:87], v[92:95], v[32:39], v20
    s_cmp_lt_u32 s65, 0x20000
    s_cbranch_scc1 F_pv
    s_nop 11
    v_rcp_f32 v161, v80
    s_branch B_fin
.section .rodata,"a"
.p2align 6
.amdhsa_kernel parallel_sum__grouped_kv_mqa__dense_activation_squared_relu__prompt_kernel
.amdhsa_next_free_vgpr 168
.amdhsa_next_free_sgpr 102
.amdhsa_accum_offset 168
.amdhsa_group_segment_fixed_size 0
.amdhsa_kernarg_size 104
.amdhsa_user_sgpr_count 2
.amdhsa_user_sgpr_kernarg_segment_ptr 1
.amdhsa_system_sgpr_workgroup_id_x 1
.end_amdhsa_kernel
.text
```
